```python
import torch

def _softmax(x, axis=-1):
    return torch.softmax(x, dim=axis)
def _gelu(x):
    return torch.nn.functional.gelu(x, approximate="tanh")
def _silu(x):
    return torch.nn.functional.silu(x)
def _sigmoid(x):
    return torch.sigmoid(x)
def _layernorm(x, axis=-1, eps=1e-5):
    m = x.mean(dim=axis, keepdim=True)
    v = x.var(dim=axis, keepdim=True, unbiased=False)
    return (x - m) / torch.sqrt(v + eps)
def _scatter_add(tgt, idx, src, axis=0):
    return tgt.clone().index_add_(axis, idx, src)
def _segment_sum(src, seg, n):
    out = torch.zeros((n,) + src.shape[1:], dtype=src.dtype)
    return out.index_add_(0, seg, src)
def _pad(x, pw):
    flat = tuple(v for pair in reversed(pw) for v in pair)
    return torch.nn.functional.pad(x, flat)

kernel_name = 'concat_heads__compressed_kv_cla__sliding_block_cached__decode'

def setup_inputs():

    _w = (lambda a: (lambda t: t.to(torch.bfloat16) if t.is_floating_point() else t)(torch.as_tensor(a)))
    def _A_setup():
        B, H, Sq, Sk, D, M = 2, 32, 1, 8192, 128, 512
        Dc = 4 * D
        return {
            "x": _w((lambda *s: torch.randn(*s, dtype=torch.bfloat16) * 3.2)(B, Sq, M)),
            "c_kv": _w((lambda *s: torch.randn(*s, dtype=torch.bfloat16) * 0.1)(B, Sk, Dc)),
            "w_q": _w((lambda *s: torch.randn(*s, dtype=torch.bfloat16) * 6.4)(M, H, D) * (M ** -0.5)),
            "w_uk": _w((lambda *s: torch.randn(*s, dtype=torch.bfloat16) * 6.4)(Dc, H, D) * (Dc ** -0.5)),
            "w_uv": _w((lambda *s: torch.randn(*s, dtype=torch.bfloat16) * 0.1)(Dc, H, D) * (Dc ** -0.5)),
            "w_o": _w((lambda *s: torch.randn(*s, dtype=torch.bfloat16) * 0.1)(H, D, M) * ((H * D) ** -0.5)),
        }
    _A_in = _A_setup()

    def _B_setup():
        B, Sq, D = 2, 1, 512
        Hq, Hkv, Sk, Dh = 32, 8, 8192, 128
        assert Hq % Hkv == 0, (Hq, Hkv)
        return {
            "x": _w((lambda *s: torch.randn(*s, dtype=torch.bfloat16) * 1.6)(B, Sq, D)),
            "k_cache": _w((lambda *s: torch.randn(*s, dtype=torch.bfloat16) * 1.6)(B, Hkv, Sk, Dh)),
            "v_cache": _w((lambda *s: torch.randn(*s, dtype=torch.bfloat16) * 0.05)(B, Hkv, Sk, Dh)),
            "wq": _w((lambda *s: torch.randn(*s, dtype=torch.bfloat16) * 1.6)(D, Hq * Dh) * (D ** -0.5)),
            "wo": _w((lambda *s: torch.randn(*s, dtype=torch.bfloat16) * 0.05)(Hq * Dh, D) * ((Hq * Dh) ** -0.5)),
        }
    _B_in = _B_setup()

    return {
        "A_x": _A_in["x"],
        "A_c_kv": _A_in["c_kv"],
        "A_w_q": _A_in["w_q"],
        "A_w_uk": _A_in["w_uk"],
        "A_w_uv": _A_in["w_uv"],
        "A_w_o": _A_in["w_o"],
        "B_x": _B_in["x"],
        "B_k_cache": _B_in["k_cache"],
        "B_v_cache": _B_in["v_cache"],
        "B_wq": _B_in["wq"],
        "B_wo": _B_in["wo"],
    }

def reference(A_x, A_c_kv, A_w_q, A_w_uk, A_w_uv, A_w_o, B_x, B_k_cache, B_v_cache, B_wq, B_wo):
    def _A_ref(x, c_kv, w_q, w_uk, w_uv, w_o):
        B, Sq, M = x.shape[0], x.shape[1], x.shape[2]
        Sk = c_kv.shape[1]
        H, D = w_q.shape[1], w_q.shape[2]
        q = torch.einsum("bqm,mhd->bhqd", x, w_q)
        k = torch.einsum("bkc,chd->bhkd", c_kv, w_uk)
        v = torch.einsum("bkc,chd->bhkd", c_kv, w_uv)
        scores = torch.einsum("bhqd,bhkd->bhqk", q, k) * (D ** -0.5)
        off = Sk - Sq
        qi = torch.arange(Sq)[:, None]
        kj = torch.arange(Sk)[None, :]
        cmask = kj <= (qi + off)
        scores = torch.where(cmask[None, None], scores, -1e9)
        p = _softmax(scores, axis=-1)
        ctx = torch.einsum("bhqk,bhkd->bhqd", p, v)
        return torch.einsum("bhqd,hdm->bqm", ctx, w_o)

    def _B_ref(x, k_cache, v_cache, wq, wo):
        B, Sq, D = x.shape
        Hq, Dh = 32, 128
        Hkv, Sk = k_cache.shape[1], k_cache.shape[2]
        W = min(4096, max(256, Sk // 4))
        rep = Hq // Hkv
        q = (lambda x, *d: x.permute(*d))((x @ wq).reshape(B, Sq, Hq, Dh), 0, 2, 1, 3)
        k = (lambda x, n, axis: torch.repeat_interleave(x, n, dim=axis))(k_cache[:, :, Sk - W:, :], rep, axis=1)
        v = (lambda x, n, axis: torch.repeat_interleave(x, n, dim=axis))(v_cache[:, :, Sk - W:, :], rep, axis=1)
        scores = torch.einsum("bhqd,bhkd->bhqk", q, k) * (Dh ** -0.5)
        p = _softmax(scores, axis=-1)
        o = torch.einsum("bhqk,bhkd->bhqd", p, v)
        return (lambda x, *d: x.permute(*d))(o, 0, 2, 1, 3).reshape(B, Sq, Hq * Dh) @ wo

    a = _A_ref(A_x, A_c_kv, A_w_q, A_w_uk, A_w_uv, A_w_o)
    b = _B_ref(B_x, B_k_cache, B_v_cache, B_wq, B_wo)
    return torch.concatenate([a, b], axis=-1)
```

```asm
; @launch grid=(256,1,1) block=(512,1,1) lds=163840
.amdgcn_target "amdgcn-amd-amdhsa--gfx950"
.text
.globl concat_heads__compressed_kv_cla__sliding_block_cached__decode_kernel
.p2align 8
.type concat_heads__compressed_kv_cla__sliding_block_cached__decode_kernel,@function
concat_heads__compressed_kv_cla__sliding_block_cached__decode_kernel:
    s_cmp_ge_u32 s2, 256
    s_cbranch_scc1 .Lend
    s_load_dwordx16 s[16:31], s[0:1], 0
    s_load_dwordx8 s[32:39], s[0:1], 64
    s_load_dwordx4 s[40:43], s[0:1], 96
    v_and_b32 v1, 63, v0
    v_lshrrev_b32 v32, 6, v0
    v_and_b32 v2, 15, v1
    v_readfirstlane_b32 s3, v32
    v_lshrrev_b32 v3, 4, v1
    v_lshlrev_b32 v33, 2, v1
    v_add_u32 v33, 152576, v33
    v_mov_b32 v34, 0
    ds_write_b32 v33, v34
    s_and_b32 s45, s2, 31
    s_lshr_b32 s46, s2, 5
    s_mov_b32 s47, 0
    s_mov_b32 s63, 0
    s_lshr_b32 s74, s2, 7
    s_and_b32 s75, s2, 15
    s_bfe_u32 s64, s2, 0x20005
    s_lshl_b32 s64, s64, 4
    s_or_b32 s75, s75, s64
    s_bfe_u32 s76, s2, 0x10004

    s_lshl_b32 s64, s3, 2
    s_lshr_b32 s62, 1697779783, s64
    s_and_b32 s62, s62, 15
    v_and_b32 v32, 1, v2
    v_bfe_u32 v33, v2, 1, 2
    v_cmp_eq_u32 vcc, 1, v32
    v_mov_b32 v34, 0x01000c0c
    v_mov_b32 v35, 0x03020c0c
    v_mov_b32 v36, 0x0c0c0100
    v_mov_b32 v37, 0x0c0c0302
    v_mov_b32 v38, 0x0c0c0c0c
    v_cndmask_b32 v34, v36, v34, vcc
    v_cndmask_b32 v35, v37, v35, vcc

    v_cmp_eq_u32 vcc, 0, v33
    s_nop 1
    v_cndmask_b32 v4, v38, v34, vcc
    v_cndmask_b32 v8, v38, v35, vcc
    v_cmp_eq_u32 vcc, 1, v33
    s_nop 1
    v_cndmask_b32 v5, v38, v34, vcc
    v_cndmask_b32 v9, v38, v35, vcc
    v_cmp_eq_u32 vcc, 2, v33
    s_nop 1
    v_cndmask_b32 v6, v38, v34, vcc
    v_cndmask_b32 v10, v38, v35, vcc
    v_cmp_eq_u32 vcc, 3, v33
    s_nop 1
    v_cndmask_b32 v7, v38, v34, vcc
    v_cndmask_b32 v11, v38, v35, vcc
    v_cmp_eq_u32 vcc, 1, v32
    v_mov_b32 v34, 0xffff0000
    v_mov_b32 v36, 0x0000ffff
    v_cndmask_b32 v34, v36, v34, vcc
    v_lshrrev_b32 v35, 1, v2

    v_cmp_eq_u32 vcc, 0, v35
    s_nop 1
    v_cndmask_b32 v12, 0, v34, vcc
    v_cmp_eq_u32 vcc, 1, v35
    s_nop 1
    v_cndmask_b32 v13, 0, v34, vcc
    v_cmp_eq_u32 vcc, 2, v35
    s_nop 1
    v_cndmask_b32 v14, 0, v34, vcc
    v_cmp_eq_u32 vcc, 3, v35
    s_nop 1
    v_cndmask_b32 v15, 0, v34, vcc
    s_waitcnt lgkmcnt(0)
    s_barrier

    s_mov_b32 s48, s42
    s_mov_b32 s49, s43
    s_mov_b32 s50, 268435456
    s_mov_b32 s51, 0x00020000
    s_cmp_eq_u32 s3, 0
    s_cbranch_scc1 .Lw0
    s_cmp_eq_u32 s3, 1
    s_cbranch_scc1 .Lw1
    s_cmp_eq_u32 s3, 2
    s_cbranch_scc1 .Lw2
    s_cmp_eq_u32 s3, 3
    s_cbranch_scc1 .Lw3
    s_branch .Lw47

.Lw0:
    s_setprio 3
    s_load_dword s44, s[42:43], 0
    s_lshl_b32 s68, s45, 8
    s_mov_b32 s56, s16
    s_mov_b32 s57, s17
    s_mov_b32 s58, 2048
    s_mov_b32 s59, 0x00020000
    s_mov_b32 s52, s20
    s_mov_b32 s53, s21
    s_mov_b32 s54, 4194304
    s_mov_b32 s55, 0x00020000
    v_lshrrev_b32 v40, 3, v2
    v_lshlrev_b32 v40, 10, v40
    v_lshl_add_u32 v40, v3, 5, v40
    s_lshl_b32 s64, s46, 7
    v_lshlrev_b32 v41, 17, v3
    v_lshl_add_u32 v41, v2, 4, v41
    s_lshl_b32 s66, s46, 19
    s_add_u32 s66, s66, s68
    s_mov_b32 s67, s66
    buffer_load_dwordx4 v[244:247], v40, s[56:59], s64 offen
    buffer_load_dwordx4 v[248:251], v40, s[56:59], s64 offen offset:16

    buffer_load_dwordx4 v[80:83], v41, s[52:55], s67 offen nt
    s_add_u32 s67, s67, 8192
    buffer_load_dwordx4 v[84:87], v41, s[52:55], s67 offen nt
    s_add_u32 s67, s67, 8192
    buffer_load_dwordx4 v[88:91], v41, s[52:55], s67 offen nt
    s_add_u32 s67, s67, 8192
    buffer_load_dwordx4 v[92:95], v41, s[52:55], s67 offen nt
    s_add_u32 s67, s67, 8192
    buffer_load_dwordx4 v[96:99], v41, s[52:55], s67 offen nt
    s_add_u32 s67, s67, 8192
    buffer_load_dwordx4 v[100:103], v41, s[52:55], s67 offen nt
    s_add_u32 s67, s67, 8192
    buffer_load_dwordx4 v[104:107], v41, s[52:55], s67 offen nt
    s_add_u32 s67, s67, 8192
    buffer_load_dwordx4 v[108:111], v41, s[52:55], s67 offen nt
    s_add_u32 s67, s67, 8192
    buffer_load_dwordx4 v[112:115], v41, s[52:55], s67 offen nt
    s_add_u32 s67, s67, 8192
    buffer_load_dwordx4 v[116:119], v41, s[52:55], s67 offen nt
    s_add_u32 s67, s67, 8192
    buffer_load_dwordx4 v[120:123], v41, s[52:55], s67 offen nt
    s_add_u32 s67, s67, 8192
    buffer_load_dwordx4 v[124:127], v41, s[52:55], s67 offen nt
    s_add_u32 s67, s67, 8192
    buffer_load_dwordx4 v[128:131], v41, s[52:55], s67 offen nt
    s_add_u32 s67, s67, 8192
    buffer_load_dwordx4 v[132:135], v41, s[52:55], s67 offen nt
    s_add_u32 s67, s67, 8192
    buffer_load_dwordx4 v[136:139], v41, s[52:55], s67 offen nt
    s_add_u32 s67, s67, 8192
    buffer_load_dwordx4 v[140:143], v41, s[52:55], s67 offen nt
    v_mov_b32 v47, 152652
    v_mov_b32 v46, 1
    ds_write_b32 v47, v46
    s_mov_b32 s56, s22
    s_mov_b32 s57, s23
    s_mov_b32 s58, 4194304
    s_mov_b32 s59, 0x00020000
    v_lshlrev_b32 v39, 15, v2
    v_lshl_add_u32 v39, v3, 4, v39
    s_mov_b32 s67, s66

    buffer_load_dwordx4 v[144:147], v39, s[56:59], s67 offen offset:0 nt
    buffer_load_dwordx4 v[148:151], v39, s[56:59], s67 offen offset:64 nt
    buffer_load_dwordx4 v[152:155], v39, s[56:59], s67 offen offset:128 nt
    buffer_load_dwordx4 v[156:159], v39, s[56:59], s67 offen offset:192 nt
    s_add_u32 s67, s67, 8192
    buffer_load_dwordx4 v[160:163], v39, s[56:59], s67 offen offset:0 nt
    buffer_load_dwordx4 v[164:167], v39, s[56:59], s67 offen offset:64 nt
    buffer_load_dwordx4 v[168:171], v39, s[56:59], s67 offen offset:128 nt
    buffer_load_dwordx4 v[172:175], v39, s[56:59], s67 offen offset:192 nt
    s_add_u32 s67, s67, 8192
    buffer_load_dwordx4 v[176:179], v39, s[56:59], s67 offen offset:0 nt
    buffer_load_dwordx4 v[180:183], v39, s[56:59], s67 offen offset:64 nt
    buffer_load_dwordx4 v[184:187], v39, s[56:59], s67 offen offset:128 nt
    buffer_load_dwordx4 v[188:191], v39, s[56:59], s67 offen offset:192 nt
    s_add_u32 s67, s67, 8192
    buffer_load_dwordx4 v[192:195], v39, s[56:59], s67 offen offset:0 nt
    buffer_load_dwordx4 v[196:199], v39, s[56:59], s67 offen offset:64 nt
    buffer_load_dwordx4 v[200:203], v39, s[56:59], s67 offen offset:128 nt
    buffer_load_dwordx4 v[204:207], v39, s[56:59], s67 offen offset:192 nt
    v_and_b32 v32, 1, v2
    v_and_b32 v33, 2, v2
    v_lshl_or_b32 v32, v33, 2, v32
    v_lshrrev_b32 v33, 1, v2
    v_and_b32 v33, 6, v33
    v_or_b32 v32, v32, v33
    v_xor_b32 v32, v32, v3
    v_lshlrev_b32 v32, 4, v32
    v_lshl_add_u32 v32, v2, 10, v32
    s_lshl_b32 s64, s62, 14

    v_xor_b32 v20, 0, v32
    v_xor_b32 v21, 64, v32
    v_xor_b32 v22, 128, v32
    v_xor_b32 v23, 192, v32
    v_add_u32 v16, s64, v20
    v_add_u32 v20, 131072, v20
    v_add_u32 v17, s64, v21
    v_add_u32 v21, 131072, v21
    v_add_u32 v18, s64, v22
    v_add_u32 v22, 131072, v22
    v_add_u32 v19, s64, v23
    v_add_u32 v23, 131072, v23
    v_lshrrev_b32 v32, 2, v1
    v_and_b32 v33, 1, v32
    v_and_b32 v34, 2, v32
    v_lshl_or_b32 v33, v34, 2, v33
    v_lshrrev_b32 v34, 1, v32
    v_and_b32 v34, 6, v34
    v_or_b32 v33, v33, v34
    v_and_b32 v34, 3, v1
    v_lshlrev_b32 v35, 1, v34
    s_and_b32 s65, s62, 1
    s_lshl_b32 s65, s65, 3
    v_or_b32 v35, s65, v35
    v_xor_b32 v35, v35, v33
    v_lshlrev_b32 v35, 4, v35
    v_lshl_add_u32 v35, v32, 10, v35
    s_lshr_b32 s65, s62, 1
    s_lshl_b32 s65, s65, 8
    v_add_u32 v35, s65, v35
    v_and_b32 v34, 1, v34
    v_lshl_or_b32 v35, v34, 3, v35

    v_xor_b32 v24, 0, v35
    v_add_u32 v28, 0x10000, v24
    v_xor_b32 v25, 8, v35
    v_add_u32 v29, 0x10000, v25
    v_xor_b32 v26, 16, v35
    v_add_u32 v30, 0x10000, v26
    v_xor_b32 v27, 24, v35
    v_add_u32 v31, 0x10000, v27
    s_waitcnt vmcnt(32)
    v_perm_b32 v32, v244, v244, v4
    v_perm_b32 v33, v244, v244, v5
    v_perm_b32 v34, v244, v244, v6
    v_perm_b32 v35, v244, v244, v7
    v_perm_b32 v36, v244, v244, v8
    v_perm_b32 v37, v244, v244, v9
    v_perm_b32 v38, v244, v244, v10
    v_perm_b32 v39, v244, v244, v11
    s_waitcnt vmcnt(31)
    v_mfma_f32_16x16x32_bf16 v[240:243], v[32:35], v[80:83], 0
    v_perm_b32 v32, v245, v245, v4
    v_perm_b32 v33, v245, v245, v5
    v_perm_b32 v34, v245, v245, v6
    v_perm_b32 v35, v245, v245, v7
    s_waitcnt vmcnt(30)
    v_mfma_f32_16x16x32_bf16 v[240:243], v[36:39], v[84:87], v[240:243]
    v_perm_b32 v36, v245, v245, v8
    v_perm_b32 v37, v245, v245, v9
    v_perm_b32 v38, v245, v245, v10
    v_perm_b32 v39, v245, v245, v11
    s_waitcnt vmcnt(29)
    v_mfma_f32_16x16x32_bf16 v[240:243], v[32:35], v[88:91], v[240:243]
    v_perm_b32 v32, v246, v246, v4
    v_perm_b32 v33, v246, v246, v5
    v_perm_b32 v34, v246, v246, v6
    v_perm_b32 v35, v246, v246, v7
    s_waitcnt vmcnt(28)
    v_mfma_f32_16x16x32_bf16 v[240:243], v[36:39], v[92:95], v[240:243]
    v_perm_b32 v36, v246, v246, v8
    v_perm_b32 v37, v246, v246, v9
    v_perm_b32 v38, v246, v246, v10
    v_perm_b32 v39, v246, v246, v11
    s_waitcnt vmcnt(27)
    v_mfma_f32_16x16x32_bf16 v[240:243], v[32:35], v[96:99], v[240:243]
    v_perm_b32 v32, v247, v247, v4
    v_perm_b32 v33, v247, v247, v5
    v_perm_b32 v34, v247, v247, v6
    v_perm_b32 v35, v247, v247, v7
    s_waitcnt vmcnt(26)
    v_mfma_f32_16x16x32_bf16 v[240:243], v[36:39], v[100:103], v[240:243]
    v_perm_b32 v36, v247, v247, v8
    v_perm_b32 v37, v247, v247, v9
    v_perm_b32 v38, v247, v247, v10
    v_perm_b32 v39, v247, v247, v11
    s_waitcnt vmcnt(25)
    v_mfma_f32_16x16x32_bf16 v[240:243], v[32:35], v[104:107], v[240:243]
    v_perm_b32 v32, v248, v248, v4
    v_perm_b32 v33, v248, v248, v5
    v_perm_b32 v34, v248, v248, v6
    v_perm_b32 v35, v248, v248, v7
    s_waitcnt vmcnt(24)
    v_mfma_f32_16x16x32_bf16 v[240:243], v[36:39], v[108:111], v[240:243]
    v_perm_b32 v36, v248, v248, v8
    v_perm_b32 v37, v248, v248, v9
    v_perm_b32 v38, v248, v248, v10
    v_perm_b32 v39, v248, v248, v11
    s_waitcnt vmcnt(23)
    v_mfma_f32_16x16x32_bf16 v[240:243], v[32:35], v[112:115], v[240:243]
    v_perm_b32 v32, v249, v249, v4
    v_perm_b32 v33, v249, v249, v5
    v_perm_b32 v34, v249, v249, v6
    v_perm_b32 v35, v249, v249, v7
    s_waitcnt vmcnt(22)
    v_mfma_f32_16x16x32_bf16 v[240:243], v[36:39], v[116:119], v[240:243]
    v_perm_b32 v36, v249, v249, v8
    v_perm_b32 v37, v249, v249, v9
    v_perm_b32 v38, v249, v249, v10
    v_perm_b32 v39, v249, v249, v11
    s_waitcnt vmcnt(21)
    v_mfma_f32_16x16x32_bf16 v[240:243], v[32:35], v[120:123], v[240:243]
    v_perm_b32 v32, v250, v250, v4
    v_perm_b32 v33, v250, v250, v5
    v_perm_b32 v34, v250, v250, v6
    v_perm_b32 v35, v250, v250, v7
    s_waitcnt vmcnt(20)
    v_mfma_f32_16x16x32_bf16 v[240:243], v[36:39], v[124:127], v[240:243]
    v_perm_b32 v36, v250, v250, v8
    v_perm_b32 v37, v250, v250, v9
    v_perm_b32 v38, v250, v250, v10
    v_perm_b32 v39, v250, v250, v11
    s_waitcnt vmcnt(19)
    v_mfma_f32_16x16x32_bf16 v[240:243], v[32:35], v[128:131], v[240:243]
    v_perm_b32 v32, v251, v251, v4
    v_perm_b32 v33, v251, v251, v5
    v_perm_b32 v34, v251, v251, v6
    v_perm_b32 v35, v251, v251, v7
    s_waitcnt vmcnt(18)
    v_mfma_f32_16x16x32_bf16 v[240:243], v[36:39], v[132:135], v[240:243]
    v_perm_b32 v36, v251, v251, v8
    v_perm_b32 v37, v251, v251, v9
    v_perm_b32 v38, v251, v251, v10
    v_perm_b32 v39, v251, v251, v11
    s_waitcnt vmcnt(17)
    v_mfma_f32_16x16x32_bf16 v[240:243], v[32:35], v[136:139], v[240:243]
    s_nop 1
    s_waitcnt vmcnt(16)
    v_mfma_f32_16x16x32_bf16 v[240:243], v[36:39], v[140:143], v[240:243]
    s_waitcnt lgkmcnt(0)
    s_add_u32 s44, s44, 2654435769
    v_lshrrev_b32 v40, 1, v3
    v_lshlrev_b32 v40, 9, v40
    v_lshl_add_u32 v40, v2, 5, v40
    v_and_b32 v41, 1, v3
    v_lshl_add_u32 v40, v41, 4, v40
    s_lshl_b32 s64, s45, 3
    s_add_u32 s64, s64, s46
    s_lshl_b32 s64, s64, 10
    s_add_u32 s64, s64, 262144

    s_nop 7
    s_nop 1
    v_cvt_pk_bf16_f32 v44, v240, v241
    v_cvt_pk_bf16_f32 v46, v242, v243
    v_mov_b32 v45, s44
    v_mov_b32 v47, s44
    s_add_u32 s69, s64, 8388608
    buffer_store_dwordx4 v[44:47], v40, s[48:51], s69 offen
    buffer_store_dwordx4 v[44:47], v40, s[48:51], s64 offen sc1
    v_lshrrev_b32 v32, 1, v2
    v_lshlrev_b32 v32, 10, v32
    v_and_b32 v33, 1, v2
    v_lshl_add_u32 v32, v33, 9, v32
    v_lshl_add_u32 v32, v3, 5, v32
    s_lshl_b32 s64, s45, 13
    s_add_u32 s64, s64, 262144

    s_add_u32 s64, s64, 8388608
    s_mov_b32 s69, 0
    s_sleep 16
.h1_1:
    buffer_load_dwordx4 v[208:211], v32, s[48:51], s64 offen offset:0 sc1
    buffer_load_dwordx4 v[212:215], v32, s[48:51], s64 offen offset:16 sc1
    buffer_load_dwordx4 v[216:219], v32, s[48:51], s64 offen offset:128 sc1
    buffer_load_dwordx4 v[220:223], v32, s[48:51], s64 offen offset:144 sc1
    buffer_load_dwordx4 v[224:227], v32, s[48:51], s64 offen offset:256 sc1
    buffer_load_dwordx4 v[228:231], v32, s[48:51], s64 offen offset:272 sc1
    buffer_load_dwordx4 v[232:235], v32, s[48:51], s64 offen offset:384 sc1
    buffer_load_dwordx4 v[236:239], v32, s[48:51], s64 offen offset:400 sc1
    s_waitcnt vmcnt(0)
    v_xor_b32 v33, s44, v209
    v_bitop3_b32 v33, v33, v211, s44 bitop3:0xf6
    v_bitop3_b32 v33, v33, v213, s44 bitop3:0xf6
    v_bitop3_b32 v33, v33, v215, s44 bitop3:0xf6
    v_bitop3_b32 v33, v33, v217, s44 bitop3:0xf6
    v_bitop3_b32 v33, v33, v219, s44 bitop3:0xf6
    v_bitop3_b32 v33, v33, v221, s44 bitop3:0xf6
    v_bitop3_b32 v33, v33, v223, s44 bitop3:0xf6
    v_bitop3_b32 v33, v33, v225, s44 bitop3:0xf6
    v_bitop3_b32 v33, v33, v227, s44 bitop3:0xf6
    v_bitop3_b32 v33, v33, v229, s44 bitop3:0xf6
    v_bitop3_b32 v33, v33, v231, s44 bitop3:0xf6
    v_bitop3_b32 v33, v33, v233, s44 bitop3:0xf6
    v_bitop3_b32 v33, v33, v235, s44 bitop3:0xf6
    v_bitop3_b32 v33, v33, v237, s44 bitop3:0xf6
    v_bitop3_b32 v33, v33, v239, s44 bitop3:0xf6
    v_cmp_ne_u32 vcc, 0, v33
    s_nop 1
    s_cbranch_vccz .tok_2
    s_add_u32 s69, s69, 1
    s_cmp_lg_u32 s69, 4
    s_cbranch_scc1 .psw_3
    s_sub_u32 s64, s64, 8388608
.psw_3:
    s_add_u32 s47, s47, 1
    s_cmp_lt_u32 s47, 2000000
    s_cbranch_scc1 .h1_1
    s_branch .Lend
.tok_2:
    v_mov_b32 v47, 152648
    v_mov_b32 v46, 1
    ds_write_b32 v47, v46
    v_mov_b32 v209, v210
    v_mov_b32 v210, v212
    v_mov_b32 v211, v214
    v_mov_b32 v217, v218
    v_mov_b32 v218, v220
    v_mov_b32 v219, v222
    v_mov_b32 v225, v226
    v_mov_b32 v226, v228
    v_mov_b32 v227, v230
    v_mov_b32 v233, v234
    v_mov_b32 v234, v236
    v_mov_b32 v235, v238
    s_nop 1
    v_mfma_f32_16x16x32_bf16 v[48:51], v[208:211], v[144:147], 0
    v_mfma_f32_16x16x32_bf16 v[52:55], v[208:211], v[160:163], 0
    v_mfma_f32_16x16x32_bf16 v[56:59], v[208:211], v[176:179], 0
    v_mfma_f32_16x16x32_bf16 v[60:63], v[208:211], v[192:195], 0
    v_mfma_f32_16x16x32_bf16 v[48:51], v[216:219], v[148:151], v[48:51]
    v_mfma_f32_16x16x32_bf16 v[52:55], v[216:219], v[164:167], v[52:55]
    v_mfma_f32_16x16x32_bf16 v[56:59], v[216:219], v[180:183], v[56:59]
    v_mfma_f32_16x16x32_bf16 v[60:63], v[216:219], v[196:199], v[60:63]
    v_mfma_f32_16x16x32_bf16 v[48:51], v[224:227], v[152:155], v[48:51]
    v_mfma_f32_16x16x32_bf16 v[52:55], v[224:227], v[168:171], v[52:55]
    v_mfma_f32_16x16x32_bf16 v[56:59], v[224:227], v[184:187], v[56:59]
    v_mfma_f32_16x16x32_bf16 v[60:63], v[224:227], v[200:203], v[60:63]
    v_mfma_f32_16x16x32_bf16 v[48:51], v[232:235], v[156:159], v[48:51]
    v_mfma_f32_16x16x32_bf16 v[52:55], v[232:235], v[172:175], v[52:55]
    v_mfma_f32_16x16x32_bf16 v[56:59], v[232:235], v[188:191], v[56:59]
    v_mfma_f32_16x16x32_bf16 v[60:63], v[232:235], v[204:207], v[60:63]
    s_nop 7
    s_nop 1
    v_add_f32 v48, v48, v50
    v_add_f32 v49, v49, v51
    v_add_f32 v52, v52, v54
    v_add_f32 v53, v53, v55
    v_add_f32 v56, v56, v58
    v_add_f32 v57, v57, v59
    v_add_f32 v60, v60, v62
    v_add_f32 v61, v61, v63
    s_nop 1
    v_permlane32_swap_b32 v48, v49
    v_permlane32_swap_b32 v52, v53
    v_permlane32_swap_b32 v56, v57
    v_permlane32_swap_b32 v60, v61
    s_nop 1
    v_add_f32 v48, v48, v49
    v_add_f32 v52, v52, v53
    v_add_f32 v56, v56, v57
    v_add_f32 v60, v60, v61
    v_mov_b32 v49, v48
    v_mov_b32 v53, v52
    v_mov_b32 v57, v56
    v_mov_b32 v61, v60
    s_nop 1
    v_permlane16_swap_b32 v48, v49
    v_permlane16_swap_b32 v52, v53
    v_permlane16_swap_b32 v56, v57
    v_permlane16_swap_b32 v60, v61
    s_nop 1
    v_add_f32 v48, v48, v49
    v_mul_f32 v48, 1040356334, v48
    v_add_f32 v52, v52, v53
    v_mul_f32 v52, 1040356334, v52
    v_add_f32 v56, v56, v57
    v_mul_f32 v56, 1040356334, v56
    v_add_f32 v60, v60, v61
    v_mul_f32 v60, 1040356334, v60
    v_cvt_pk_bf16_f32 v36, v48, v52
    v_cvt_pk_bf16_f32 v38, v56, v60
    v_mov_b32 v37, s44
    v_mov_b32 v39, s44
    v_lshrrev_b32 v32, 1, v3
    v_lshlrev_b32 v32, 16, v32
    v_lshl_add_u32 v32, v2, 4, v32
    s_lshl_b32 s64, s45, 3
    s_add_u32 s64, s64, s46
    s_lshl_b32 s64, s64, 8
    s_add_u32 s64, s64, 786432

    v_and_b32 v33, 1, v3
    v_cmp_eq_u32 vcc, 0, v33
    s_and_saveexec_b64 s[70:71], vcc
    buffer_store_dwordx4 v[36:39], v32, s[48:51], s64 offen sc1
    s_mov_b64 exec, s[70:71]
    s_lshr_b32 s64, s45, 4
    s_lshl_b32 s64, s64, 11
    s_and_b32 s65, s45, 15
    s_lshl_b32 s65, s65, 2
    s_add_u32 s64, s64, s65
    s_add_u32 s64, s64, 73728
    s_and_b32 s65, s45, 7

    s_cmp_eq_u32 s65, s46
    s_cbranch_scc0 .pf_4
    v_lshlrev_b32 v47, 7, v1
    v_mov_b32 v46, s44
    s_mov_b64 exec, 65535
    buffer_store_dword v46, v47, s[48:51], s64 offen sc1
    s_mov_b64 exec, -1
.pf_4:
    s_cmp_ge_u32 s63, 2
    s_cbranch_scc1 .wl_5
    v_mov_b32 v47, 152576
.wf_6:
    ds_read_b32 v46, v47
    s_waitcnt lgkmcnt(0)
    v_readfirstlane_b32 s63, v46
    s_nop 1
    s_cmp_ge_u32 s63, 2
    s_cbranch_scc1 .wfok_7
    s_add_u32 s47, s47, 1
    s_cmp_lt_u32 s47, 2000000
    s_cbranch_scc1 .wf_6
    s_branch .Lend
.wfok_7:
.wl_5:
    ds_read_b64_tr_b16 v[144:145], v24 offset:0
    ds_read_b64_tr_b16 v[146:147], v24 offset:16384
    ds_read_b64_tr_b16 v[148:149], v25 offset:0
    ds_read_b64_tr_b16 v[150:151], v25 offset:16384
    ds_read_b64_tr_b16 v[152:153], v26 offset:0
    ds_read_b64_tr_b16 v[154:155], v26 offset:16384
    ds_read_b64_tr_b16 v[156:157], v27 offset:0
    ds_read_b64_tr_b16 v[158:159], v27 offset:16384
    s_lshr_b32 s65, s62, 1
    s_cmp_lg_u32 s65, 0
    s_cbranch_scc1 .ps_8
    s_waitcnt lgkmcnt(0)
    ds_read_b128 v[80:83], v16 offset:0
    ds_read_b128 v[84:87], v17 offset:0
    ds_read_b128 v[88:91], v18 offset:0
    ds_read_b128 v[92:95], v19 offset:0
    ds_read_b128 v[96:99], v16 offset:256
    ds_read_b128 v[100:103], v17 offset:256
    ds_read_b128 v[104:107], v18 offset:256
    ds_read_b128 v[108:111], v19 offset:256
    ds_read_b128 v[112:115], v16 offset:512
    ds_read_b128 v[116:119], v17 offset:512
    ds_read_b128 v[120:123], v18 offset:512
    ds_read_b128 v[124:127], v19 offset:512
    s_waitcnt lgkmcnt(4)
    ds_read_b128 v[128:131], v16 offset:768
    ds_read_b128 v[132:135], v17 offset:768
    ds_read_b128 v[136:139], v18 offset:768
    ds_read_b128 v[140:143], v19 offset:768
.ps_8:
    s_waitcnt lgkmcnt(0)
    v_mov_b32 v47, 152636
    v_mov_b32 v46, 1
    s_mov_b64 exec, 1
    ds_add_u32 v47, v46
    s_mov_b64 exec, -1
    s_cmp_ge_u32 s63, 4
    s_cbranch_scc1 .wl_9
    v_mov_b32 v47, 152576
.wf_10:
    ds_read_b32 v46, v47
    s_waitcnt lgkmcnt(0)
    v_readfirstlane_b32 s63, v46
    s_nop 1
    s_cmp_ge_u32 s63, 4
    s_cbranch_scc1 .wfok_11
    s_add_u32 s47, s47, 1
    s_cmp_lt_u32 s47, 2000000
    s_cbranch_scc1 .wf_10
    s_branch .Lend
.wfok_11:
.wl_9:
    ds_read_b64_tr_b16 v[160:161], v24 offset:32768
    ds_read_b64_tr_b16 v[162:163], v24 offset:49152
    ds_read_b64_tr_b16 v[164:165], v25 offset:32768
    ds_read_b64_tr_b16 v[166:167], v25 offset:49152
    ds_read_b64_tr_b16 v[168:169], v26 offset:32768
    ds_read_b64_tr_b16 v[170:171], v26 offset:49152
    ds_read_b64_tr_b16 v[172:173], v27 offset:32768
    ds_read_b64_tr_b16 v[174:175], v27 offset:49152
    s_lshr_b32 s65, s62, 1
    s_cmp_lg_u32 s65, 1
    s_cbranch_scc1 .ps_12
    s_waitcnt lgkmcnt(0)
    ds_read_b128 v[80:83], v16 offset:0
    ds_read_b128 v[84:87], v17 offset:0
    ds_read_b128 v[88:91], v18 offset:0
    ds_read_b128 v[92:95], v19 offset:0
    ds_read_b128 v[96:99], v16 offset:256
    ds_read_b128 v[100:103], v17 offset:256
    ds_read_b128 v[104:107], v18 offset:256
    ds_read_b128 v[108:111], v19 offset:256
    ds_read_b128 v[112:115], v16 offset:512
    ds_read_b128 v[116:119], v17 offset:512
    ds_read_b128 v[120:123], v18 offset:512
    ds_read_b128 v[124:127], v19 offset:512
    s_waitcnt lgkmcnt(4)
    ds_read_b128 v[128:131], v16 offset:768
    ds_read_b128 v[132:135], v17 offset:768
    ds_read_b128 v[136:139], v18 offset:768
    ds_read_b128 v[140:143], v19 offset:768
.ps_12:
    s_waitcnt lgkmcnt(0)
    v_mov_b32 v47, 152640
    v_mov_b32 v46, 1
    s_mov_b64 exec, 1
    ds_add_u32 v47, v46
    s_mov_b64 exec, -1
    s_and_b32 s69, s2, 31
    s_lshl_b32 s69, s69, 7
    s_add_u32 s69, s69, 73728
    s_add_u32 s60, s42, s69
    s_addc_u32 s61, s43, 0
    s_mov_b32 s65, 0
.sg_13:
    s_load_dwordx16 s[80:95], s[60:61], 0 glc
    s_waitcnt lgkmcnt(0)
    s_cmp_lg_u32 s80, s44
    s_cbranch_scc1 .sgrt_15
    s_cmp_lg_u32 s81, s44
    s_cbranch_scc1 .sgrt_15
    s_cmp_lg_u32 s82, s44
    s_cbranch_scc1 .sgrt_15
    s_cmp_lg_u32 s83, s44
    s_cbranch_scc1 .sgrt_15
    s_cmp_lg_u32 s84, s44
    s_cbranch_scc1 .sgrt_15
    s_cmp_lg_u32 s85, s44
    s_cbranch_scc1 .sgrt_15
    s_cmp_lg_u32 s86, s44
    s_cbranch_scc1 .sgrt_15
    s_cmp_lg_u32 s87, s44
    s_cbranch_scc1 .sgrt_15
    s_cmp_lg_u32 s88, s44
    s_cbranch_scc1 .sgrt_15
    s_cmp_lg_u32 s89, s44
    s_cbranch_scc1 .sgrt_15
    s_cmp_lg_u32 s90, s44
    s_cbranch_scc1 .sgrt_15
    s_cmp_lg_u32 s91, s44
    s_cbranch_scc1 .sgrt_15
    s_cmp_lg_u32 s92, s44
    s_cbranch_scc1 .sgrt_15
    s_cmp_lg_u32 s93, s44
    s_cbranch_scc1 .sgrt_15
    s_cmp_lg_u32 s94, s44
    s_cbranch_scc1 .sgrt_15
    s_cmp_lg_u32 s95, s44
    s_cbranch_scc1 .sgrt_15
    s_branch .sgok_14
.sgrt_15:
    s_sleep 2
    s_add_u32 s65, s65, 1
    s_cmp_lt_u32 s65, 4000
    s_cbranch_scc1 .sg_13
.sgok_14:
    v_mov_b32 v47, 152624
    v_mov_b32 v46, 1
    ds_write_b32 v47, v46
    s_lshl_b32 s64, s74, 5
    s_lshl_b32 s65, s76, 4
    s_add_u32 s64, s64, s65
    s_add_u32 s64, s64, 0
    s_lshl_b32 s64, s64, 11
    s_add_u32 s64, s64, 786432
    v_lshlrev_b32 v32, 4, v1

    s_add_u32 s66, s64, 0
    buffer_load_dwordx4 v[208:211], v32, s[48:51], s66 offen offset:0 sc1
    buffer_load_dwordx4 v[212:215], v32, s[48:51], s66 offen offset:1024 sc1
    buffer_load_dwordx4 v[216:219], v32, s[48:51], s66 offen offset:2048 sc1
    buffer_load_dwordx4 v[220:223], v32, s[48:51], s66 offen offset:3072 sc1
    s_add_u32 s66, s64, 4096
    buffer_load_dwordx4 v[224:227], v32, s[48:51], s66 offen offset:0 sc1
    buffer_load_dwordx4 v[228:231], v32, s[48:51], s66 offen offset:1024 sc1
    buffer_load_dwordx4 v[232:235], v32, s[48:51], s66 offen offset:2048 sc1
    buffer_load_dwordx4 v[236:239], v32, s[48:51], s66 offen offset:3072 sc1
    s_add_u32 s66, s64, 8192
    buffer_load_dwordx4 v[48:51], v32, s[48:51], s66 offen offset:0 sc1
    buffer_load_dwordx4 v[52:55], v32, s[48:51], s66 offen offset:1024 sc1
    buffer_load_dwordx4 v[56:59], v32, s[48:51], s66 offen offset:2048 sc1
    buffer_load_dwordx4 v[60:63], v32, s[48:51], s66 offen offset:3072 sc1
    s_add_u32 s66, s64, 12288
    buffer_load_dwordx4 v[64:67], v32, s[48:51], s66 offen offset:0 sc1
    buffer_load_dwordx4 v[68:71], v32, s[48:51], s66 offen offset:1024 sc1
    buffer_load_dwordx4 v[72:75], v32, s[48:51], s66 offen offset:2048 sc1
    buffer_load_dwordx4 v[76:79], v32, s[48:51], s66 offen offset:3072 sc1
    v_mov_b32 v47, 152632
    v_mov_b32 v46, 1
    s_mov_b64 exec, 1
    ds_add_u32 v47, v46
    s_mov_b64 exec, -1
    s_cmp_ge_u32 s63, 6
    s_cbranch_scc1 .wl_16
    v_mov_b32 v47, 152576
.wf_17:
    ds_read_b32 v46, v47
    s_waitcnt lgkmcnt(0)
    v_readfirstlane_b32 s63, v46
    s_nop 1
    s_cmp_ge_u32 s63, 6
    s_cbranch_scc1 .wfok_18
    s_add_u32 s47, s47, 1
    s_cmp_lt_u32 s47, 2000000
    s_cbranch_scc1 .wf_17
    s_branch .Lend
.wfok_18:
.wl_16:
    ds_read_b64_tr_b16 v[176:177], v28 offset:0
    ds_read_b64_tr_b16 v[178:179], v28 offset:16384
    ds_read_b64_tr_b16 v[180:181], v29 offset:0
    ds_read_b64_tr_b16 v[182:183], v29 offset:16384
    ds_read_b64_tr_b16 v[184:185], v30 offset:0
    ds_read_b64_tr_b16 v[186:187], v30 offset:16384
    ds_read_b64_tr_b16 v[188:189], v31 offset:0
    ds_read_b64_tr_b16 v[190:191], v31 offset:16384
    s_lshr_b32 s65, s62, 1
    s_cmp_lg_u32 s65, 2
    s_cbranch_scc1 .ps_19
    s_waitcnt lgkmcnt(0)
    ds_read_b128 v[80:83], v16 offset:0
    ds_read_b128 v[84:87], v17 offset:0
    ds_read_b128 v[88:91], v18 offset:0
    ds_read_b128 v[92:95], v19 offset:0
    ds_read_b128 v[96:99], v16 offset:256
    ds_read_b128 v[100:103], v17 offset:256
    ds_read_b128 v[104:107], v18 offset:256
    ds_read_b128 v[108:111], v19 offset:256
    ds_read_b128 v[112:115], v16 offset:512
    ds_read_b128 v[116:119], v17 offset:512
    ds_read_b128 v[120:123], v18 offset:512
    ds_read_b128 v[124:127], v19 offset:512
    s_waitcnt lgkmcnt(4)
    ds_read_b128 v[128:131], v16 offset:768
    ds_read_b128 v[132:135], v17 offset:768
    ds_read_b128 v[136:139], v18 offset:768
    ds_read_b128 v[140:143], v19 offset:768
.ps_19:
    s_waitcnt lgkmcnt(0)
    v_mov_b32 v47, 152644
    v_mov_b32 v46, 1
    s_mov_b64 exec, 1
    ds_add_u32 v47, v46
    s_mov_b64 exec, -1
    v_lshrrev_b32 v34, 5, v1
    v_lshlrev_b32 v34, 8, v34
    v_and_b32 v35, 1, v3
    v_lshl_add_u32 v34, v35, 7, v34
    v_lshrrev_b32 v35, 1, v2
    v_lshl_add_u32 v34, v35, 4, v34
    v_and_b32 v35, 1, v1
    v_lshl_add_u32 v34, v35, 3, v34
    s_waitcnt vmcnt(0)

    s_branch .h2chk_20
.h2_21:
    s_add_u32 s66, s64, 0
    buffer_load_dwordx4 v[208:211], v32, s[48:51], s66 offen offset:0 sc1
    buffer_load_dwordx4 v[212:215], v32, s[48:51], s66 offen offset:1024 sc1
    buffer_load_dwordx4 v[216:219], v32, s[48:51], s66 offen offset:2048 sc1
    buffer_load_dwordx4 v[220:223], v32, s[48:51], s66 offen offset:3072 sc1
    s_add_u32 s66, s64, 4096
    buffer_load_dwordx4 v[224:227], v32, s[48:51], s66 offen offset:0 sc1
    buffer_load_dwordx4 v[228:231], v32, s[48:51], s66 offen offset:1024 sc1
    buffer_load_dwordx4 v[232:235], v32, s[48:51], s66 offen offset:2048 sc1
    buffer_load_dwordx4 v[236:239], v32, s[48:51], s66 offen offset:3072 sc1
    s_add_u32 s66, s64, 8192
    buffer_load_dwordx4 v[48:51], v32, s[48:51], s66 offen offset:0 sc1
    buffer_load_dwordx4 v[52:55], v32, s[48:51], s66 offen offset:1024 sc1
    buffer_load_dwordx4 v[56:59], v32, s[48:51], s66 offen offset:2048 sc1
    buffer_load_dwordx4 v[60:63], v32, s[48:51], s66 offen offset:3072 sc1
    s_add_u32 s66, s64, 12288
    buffer_load_dwordx4 v[64:67], v32, s[48:51], s66 offen offset:0 sc1
    buffer_load_dwordx4 v[68:71], v32, s[48:51], s66 offen offset:1024 sc1
    buffer_load_dwordx4 v[72:75], v32, s[48:51], s66 offen offset:2048 sc1
    buffer_load_dwordx4 v[76:79], v32, s[48:51], s66 offen offset:3072 sc1
    s_waitcnt vmcnt(0)
.h2chk_20:
    v_xor_b32 v33, s44, v209
    v_bitop3_b32 v33, v33, v211, s44 bitop3:0xf6
    v_bitop3_b32 v33, v33, v213, s44 bitop3:0xf6
    v_bitop3_b32 v33, v33, v215, s44 bitop3:0xf6
    v_bitop3_b32 v33, v33, v217, s44 bitop3:0xf6
    v_bitop3_b32 v33, v33, v219, s44 bitop3:0xf6
    v_bitop3_b32 v33, v33, v221, s44 bitop3:0xf6
    v_bitop3_b32 v33, v33, v223, s44 bitop3:0xf6
    v_bitop3_b32 v33, v33, v225, s44 bitop3:0xf6
    v_bitop3_b32 v33, v33, v227, s44 bitop3:0xf6
    v_bitop3_b32 v33, v33, v229, s44 bitop3:0xf6
    v_bitop3_b32 v33, v33, v231, s44 bitop3:0xf6
    v_bitop3_b32 v33, v33, v233, s44 bitop3:0xf6
    v_bitop3_b32 v33, v33, v235, s44 bitop3:0xf6
    v_bitop3_b32 v33, v33, v237, s44 bitop3:0xf6
    v_bitop3_b32 v33, v33, v239, s44 bitop3:0xf6
    v_bitop3_b32 v33, v33, v49, s44 bitop3:0xf6
    v_bitop3_b32 v33, v33, v51, s44 bitop3:0xf6
    v_bitop3_b32 v33, v33, v53, s44 bitop3:0xf6
    v_bitop3_b32 v33, v33, v55, s44 bitop3:0xf6
    v_bitop3_b32 v33, v33, v57, s44 bitop3:0xf6
    v_bitop3_b32 v33, v33, v59, s44 bitop3:0xf6
    v_bitop3_b32 v33, v33, v61, s44 bitop3:0xf6
    v_bitop3_b32 v33, v33, v63, s44 bitop3:0xf6
    v_bitop3_b32 v33, v33, v65, s44 bitop3:0xf6
    v_bitop3_b32 v33, v33, v67, s44 bitop3:0xf6
    v_bitop3_b32 v33, v33, v69, s44 bitop3:0xf6
    v_bitop3_b32 v33, v33, v71, s44 bitop3:0xf6
    v_bitop3_b32 v33, v33, v73, s44 bitop3:0xf6
    v_bitop3_b32 v33, v33, v75, s44 bitop3:0xf6
    v_bitop3_b32 v33, v33, v77, s44 bitop3:0xf6
    v_bitop3_b32 v33, v33, v79, s44 bitop3:0xf6
    v_cmp_ne_u32 vcc, 0, v33
    s_nop 1
    s_cbranch_vccz .tok_22
    s_sleep 2
    s_add_u32 s47, s47, 1
    s_cmp_lt_u32 s47, 2000000
    s_cbranch_scc1 .h2_21
    s_branch .Lend
.tok_22:
    v_xor_b32 v36, 0, v34
    v_add_u32 v36, 131072, v36
    ds_write2_b32 v36, v208, v210 offset0:0 offset1:1
    ds_write2_b32 v36, v212, v214 offset0:128 offset1:129
    v_xor_b32 v37, 16, v34
    v_add_u32 v37, 132096, v37
    ds_write2_b32 v37, v216, v218 offset0:0 offset1:1
    ds_write2_b32 v37, v220, v222 offset0:128 offset1:129
    v_xor_b32 v36, 128, v34
    v_add_u32 v36, 133120, v36
    ds_write2_b32 v36, v224, v226 offset0:0 offset1:1
    ds_write2_b32 v36, v228, v230 offset0:128 offset1:129
    v_xor_b32 v37, 144, v34
    v_add_u32 v37, 134144, v37
    ds_write2_b32 v37, v232, v234 offset0:0 offset1:1
    ds_write2_b32 v37, v236, v238 offset0:128 offset1:129
    s_waitcnt lgkmcnt(4)
    v_xor_b32 v36, 32, v34
    v_add_u32 v36, 135168, v36
    ds_write2_b32 v36, v48, v50 offset0:0 offset1:1
    ds_write2_b32 v36, v52, v54 offset0:128 offset1:129
    v_xor_b32 v37, 48, v34
    v_add_u32 v37, 136192, v37
    ds_write2_b32 v37, v56, v58 offset0:0 offset1:1
    ds_write2_b32 v37, v60, v62 offset0:128 offset1:129
    v_xor_b32 v36, 160, v34
    v_add_u32 v36, 137216, v36
    ds_write2_b32 v36, v64, v66 offset0:0 offset1:1
    ds_write2_b32 v36, v68, v70 offset0:128 offset1:129
    v_xor_b32 v37, 176, v34
    v_add_u32 v37, 138240, v37
    ds_write2_b32 v37, v72, v74 offset0:0 offset1:1
    ds_write2_b32 v37, v76, v78 offset0:128 offset1:129
    s_waitcnt lgkmcnt(4)
    s_waitcnt lgkmcnt(0)
    v_mov_b32 v47, 152580
    v_mov_b32 v46, 1
    s_mov_b64 exec, 1
    ds_add_u32 v47, v46
    s_mov_b64 exec, -1
    s_cmp_lt_u32 s62, 6
    s_cbranch_scc1 .ol_23
    s_add_u32 s64, s62, 1
    s_cmp_ge_u32 s63, s64
    s_cbranch_scc1 .ol2_24
    v_mov_b32 v47, 152576
.wf_25:
    ds_read_b32 v46, v47
    s_waitcnt lgkmcnt(0)
    v_readfirstlane_b32 s63, v46
    s_nop 1
    s_cmp_ge_u32 s63, s64
    s_cbranch_scc1 .wfok_26
    s_add_u32 s47, s47, 1
    s_cmp_lt_u32 s47, 2000000
    s_cbranch_scc1 .wf_25
    s_branch .Lend
.wfok_26:
.ol2_24:
    ds_read_b128 v[80:83], v16 offset:0
    ds_read_b128 v[84:87], v17 offset:0
    ds_read_b128 v[88:91], v18 offset:0
    ds_read_b128 v[92:95], v19 offset:0
    ds_read_b128 v[96:99], v16 offset:256
    ds_read_b128 v[100:103], v17 offset:256
    ds_read_b128 v[104:107], v18 offset:256
    ds_read_b128 v[108:111], v19 offset:256
    ds_read_b128 v[112:115], v16 offset:512
    ds_read_b128 v[116:119], v17 offset:512
    ds_read_b128 v[120:123], v18 offset:512
    ds_read_b128 v[124:127], v19 offset:512
    s_waitcnt lgkmcnt(4)
    ds_read_b128 v[128:131], v16 offset:768
    ds_read_b128 v[132:135], v17 offset:768
    ds_read_b128 v[136:139], v18 offset:768
    ds_read_b128 v[140:143], v19 offset:768
.ol_23:
    s_branch .Lattn_s
.Lw1:
    s_load_dword s44, s[42:43], 0
    s_and_b32 s72, s2, 7
    s_lshl_b32 s72, s72, 2
    s_bfe_u32 s73, s2, 0x20003
    s_add_u32 s72, s72, s73
    s_lshl_b32 s68, s72, 8
    v_mov_b32 v47, 152616
.wf_27:
    ds_read_b32 v46, v47
    s_waitcnt lgkmcnt(0)
    v_readfirstlane_b32 s65, v46
    s_nop 1
    s_cmp_ge_u32 s65, 16
    s_cbranch_scc1 .wfok_28
    s_sleep 1
    s_add_u32 s47, s47, 1
    s_cmp_lt_u32 s47, 2000000
    s_cbranch_scc1 .wf_27
    s_branch .Lend
.wfok_28:
    s_mov_b32 s56, s28
    s_mov_b32 s57, s29
    s_mov_b32 s58, 2048
    s_mov_b32 s59, 0x00020000
    s_mov_b32 s52, s34
    s_mov_b32 s53, s35
    s_mov_b32 s54, 4194304
    s_mov_b32 s55, 0x00020000
    v_lshrrev_b32 v40, 3, v2
    v_lshlrev_b32 v40, 10, v40
    v_lshl_add_u32 v40, v3, 5, v40
    s_lshl_b32 s64, s46, 7
    v_lshlrev_b32 v41, 17, v3
    v_lshl_add_u32 v41, v2, 4, v41
    s_lshl_b32 s66, s46, 19
    s_add_u32 s66, s66, s68
    s_mov_b32 s67, s66
    buffer_load_dwordx4 v[244:247], v40, s[56:59], s64 offen
    buffer_load_dwordx4 v[248:251], v40, s[56:59], s64 offen offset:16

    buffer_load_dwordx4 v[80:83], v41, s[52:55], s67 offen nt
    s_add_u32 s67, s67, 8192
    buffer_load_dwordx4 v[84:87], v41, s[52:55], s67 offen nt
    s_add_u32 s67, s67, 8192
    buffer_load_dwordx4 v[88:91], v41, s[52:55], s67 offen nt
    s_add_u32 s67, s67, 8192
    buffer_load_dwordx4 v[92:95], v41, s[52:55], s67 offen nt
    s_add_u32 s67, s67, 8192
    buffer_load_dwordx4 v[96:99], v41, s[52:55], s67 offen nt
    s_add_u32 s67, s67, 8192
    buffer_load_dwordx4 v[100:103], v41, s[52:55], s67 offen nt
    s_add_u32 s67, s67, 8192
    buffer_load_dwordx4 v[104:107], v41, s[52:55], s67 offen nt
    s_add_u32 s67, s67, 8192
    buffer_load_dwordx4 v[108:111], v41, s[52:55], s67 offen nt
    s_add_u32 s67, s67, 8192
    buffer_load_dwordx4 v[112:115], v41, s[52:55], s67 offen nt
    s_add_u32 s67, s67, 8192
    buffer_load_dwordx4 v[116:119], v41, s[52:55], s67 offen nt
    s_add_u32 s67, s67, 8192
    buffer_load_dwordx4 v[120:123], v41, s[52:55], s67 offen nt
    s_add_u32 s67, s67, 8192
    buffer_load_dwordx4 v[124:127], v41, s[52:55], s67 offen nt
    s_add_u32 s67, s67, 8192
    buffer_load_dwordx4 v[128:131], v41, s[52:55], s67 offen nt
    s_add_u32 s67, s67, 8192
    buffer_load_dwordx4 v[132:135], v41, s[52:55], s67 offen nt
    s_add_u32 s67, s67, 8192
    buffer_load_dwordx4 v[136:139], v41, s[52:55], s67 offen nt
    s_add_u32 s67, s67, 8192
    buffer_load_dwordx4 v[140:143], v41, s[52:55], s67 offen nt
    v_and_b32 v32, 1, v2
    v_and_b32 v33, 2, v2
    v_lshl_or_b32 v32, v33, 2, v32
    v_lshrrev_b32 v33, 1, v2
    v_and_b32 v33, 6, v33
    v_or_b32 v32, v32, v33
    v_xor_b32 v32, v32, v3
    v_lshlrev_b32 v32, 4, v32
    v_lshl_add_u32 v32, v2, 10, v32
    s_lshl_b32 s64, s62, 14

    v_xor_b32 v20, 0, v32
    v_xor_b32 v21, 64, v32
    v_xor_b32 v22, 128, v32
    v_xor_b32 v23, 192, v32
    v_add_u32 v16, s64, v20
    v_add_u32 v20, 131072, v20
    v_add_u32 v17, s64, v21
    v_add_u32 v21, 131072, v21
    v_add_u32 v18, s64, v22
    v_add_u32 v22, 131072, v22
    v_add_u32 v19, s64, v23
    v_add_u32 v23, 131072, v23
    v_lshrrev_b32 v32, 2, v1
    v_and_b32 v33, 1, v32
    v_and_b32 v34, 2, v32
    v_lshl_or_b32 v33, v34, 2, v33
    v_lshrrev_b32 v34, 1, v32
    v_and_b32 v34, 6, v34
    v_or_b32 v33, v33, v34
    v_and_b32 v34, 3, v1
    v_lshlrev_b32 v35, 1, v34
    s_and_b32 s65, s62, 1
    s_lshl_b32 s65, s65, 3
    v_or_b32 v35, s65, v35
    v_xor_b32 v35, v35, v33
    v_lshlrev_b32 v35, 4, v35
    v_lshl_add_u32 v35, v32, 10, v35
    s_lshr_b32 s65, s62, 1
    s_lshl_b32 s65, s65, 8
    v_add_u32 v35, s65, v35
    v_and_b32 v34, 1, v34
    v_lshl_or_b32 v35, v34, 3, v35

    v_xor_b32 v24, 0, v35
    v_add_u32 v28, 0x10000, v24
    v_xor_b32 v25, 8, v35
    v_add_u32 v29, 0x10000, v25
    v_xor_b32 v26, 16, v35
    v_add_u32 v30, 0x10000, v26
    v_xor_b32 v27, 24, v35
    v_add_u32 v31, 0x10000, v27
    s_waitcnt vmcnt(16)
    v_perm_b32 v32, v244, v244, v4
    v_perm_b32 v33, v244, v244, v5
    v_perm_b32 v34, v244, v244, v6
    v_perm_b32 v35, v244, v244, v7
    v_perm_b32 v36, v244, v244, v8
    v_perm_b32 v37, v244, v244, v9
    v_perm_b32 v38, v244, v244, v10
    v_perm_b32 v39, v244, v244, v11
    s_waitcnt vmcnt(15)
    v_mfma_f32_16x16x32_bf16 v[240:243], v[32:35], v[80:83], 0
    v_perm_b32 v32, v245, v245, v4
    v_perm_b32 v33, v245, v245, v5
    v_perm_b32 v34, v245, v245, v6
    v_perm_b32 v35, v245, v245, v7
    s_waitcnt vmcnt(14)
    v_mfma_f32_16x16x32_bf16 v[240:243], v[36:39], v[84:87], v[240:243]
    v_perm_b32 v36, v245, v245, v8
    v_perm_b32 v37, v245, v245, v9
    v_perm_b32 v38, v245, v245, v10
    v_perm_b32 v39, v245, v245, v11
    s_waitcnt vmcnt(13)
    v_mfma_f32_16x16x32_bf16 v[240:243], v[32:35], v[88:91], v[240:243]
    v_perm_b32 v32, v246, v246, v4
    v_perm_b32 v33, v246, v246, v5
    v_perm_b32 v34, v246, v246, v6
    v_perm_b32 v35, v246, v246, v7
    s_waitcnt vmcnt(12)
    v_mfma_f32_16x16x32_bf16 v[240:243], v[36:39], v[92:95], v[240:243]
    v_perm_b32 v36, v246, v246, v8
    v_perm_b32 v37, v246, v246, v9
    v_perm_b32 v38, v246, v246, v10
    v_perm_b32 v39, v246, v246, v11
    s_waitcnt vmcnt(11)
    v_mfma_f32_16x16x32_bf16 v[240:243], v[32:35], v[96:99], v[240:243]
    v_perm_b32 v32, v247, v247, v4
    v_perm_b32 v33, v247, v247, v5
    v_perm_b32 v34, v247, v247, v6
    v_perm_b32 v35, v247, v247, v7
    s_waitcnt vmcnt(10)
    v_mfma_f32_16x16x32_bf16 v[240:243], v[36:39], v[100:103], v[240:243]
    v_perm_b32 v36, v247, v247, v8
    v_perm_b32 v37, v247, v247, v9
    v_perm_b32 v38, v247, v247, v10
    v_perm_b32 v39, v247, v247, v11
    s_waitcnt vmcnt(9)
    v_mfma_f32_16x16x32_bf16 v[240:243], v[32:35], v[104:107], v[240:243]
    v_perm_b32 v32, v248, v248, v4
    v_perm_b32 v33, v248, v248, v5
    v_perm_b32 v34, v248, v248, v6
    v_perm_b32 v35, v248, v248, v7
    s_waitcnt vmcnt(8)
    v_mfma_f32_16x16x32_bf16 v[240:243], v[36:39], v[108:111], v[240:243]
    v_perm_b32 v36, v248, v248, v8
    v_perm_b32 v37, v248, v248, v9
    v_perm_b32 v38, v248, v248, v10
    v_perm_b32 v39, v248, v248, v11
    s_waitcnt vmcnt(7)
    v_mfma_f32_16x16x32_bf16 v[240:243], v[32:35], v[112:115], v[240:243]
    v_perm_b32 v32, v249, v249, v4
    v_perm_b32 v33, v249, v249, v5
    v_perm_b32 v34, v249, v249, v6
    v_perm_b32 v35, v249, v249, v7
    s_waitcnt vmcnt(6)
    v_mfma_f32_16x16x32_bf16 v[240:243], v[36:39], v[116:119], v[240:243]
    v_perm_b32 v36, v249, v249, v8
    v_perm_b32 v37, v249, v249, v9
    v_perm_b32 v38, v249, v249, v10
    v_perm_b32 v39, v249, v249, v11
    s_waitcnt vmcnt(5)
    v_mfma_f32_16x16x32_bf16 v[240:243], v[32:35], v[120:123], v[240:243]
    v_perm_b32 v32, v250, v250, v4
    v_perm_b32 v33, v250, v250, v5
    v_perm_b32 v34, v250, v250, v6
    v_perm_b32 v35, v250, v250, v7
    s_waitcnt vmcnt(4)
    v_mfma_f32_16x16x32_bf16 v[240:243], v[36:39], v[124:127], v[240:243]
    v_perm_b32 v36, v250, v250, v8
    v_perm_b32 v37, v250, v250, v9
    v_perm_b32 v38, v250, v250, v10
    v_perm_b32 v39, v250, v250, v11
    s_waitcnt vmcnt(3)
    v_mfma_f32_16x16x32_bf16 v[240:243], v[32:35], v[128:131], v[240:243]
    v_perm_b32 v32, v251, v251, v4
    v_perm_b32 v33, v251, v251, v5
    v_perm_b32 v34, v251, v251, v6
    v_perm_b32 v35, v251, v251, v7
    s_waitcnt vmcnt(2)
    v_mfma_f32_16x16x32_bf16 v[240:243], v[36:39], v[132:135], v[240:243]
    v_perm_b32 v36, v251, v251, v8
    v_perm_b32 v37, v251, v251, v9
    v_perm_b32 v38, v251, v251, v10
    v_perm_b32 v39, v251, v251, v11
    s_waitcnt vmcnt(1)
    v_mfma_f32_16x16x32_bf16 v[240:243], v[32:35], v[136:139], v[240:243]
    s_nop 1
    s_waitcnt vmcnt(0)
    v_mfma_f32_16x16x32_bf16 v[240:243], v[36:39], v[140:143], v[240:243]
    s_waitcnt lgkmcnt(0)
    s_add_u32 s44, s44, 2654435769
    v_lshrrev_b32 v40, 1, v3
    v_lshlrev_b32 v40, 9, v40
    v_lshl_add_u32 v40, v2, 5, v40
    v_and_b32 v41, 1, v3
    v_lshl_add_u32 v40, v41, 4, v40
    s_lshl_b32 s64, s72, 3
    s_add_u32 s64, s64, s46
    s_lshl_b32 s64, s64, 10
    s_add_u32 s64, s64, 524288

    s_nop 7
    s_nop 1
    v_cvt_pk_bf16_f32 v44, v240, v241
    v_cvt_pk_bf16_f32 v46, v242, v243
    v_mov_b32 v45, s44
    v_mov_b32 v47, s44
    buffer_store_dwordx4 v[44:47], v40, s[48:51], s64 offen sc1
    s_lshl_b32 s64, s72, 9
    s_lshl_b32 s65, s46, 2
    s_add_u32 s64, s64, s65
    s_add_u32 s64, s64, 90112
    v_lshlrev_b32 v47, 7, v1
    v_mov_b32 v46, s44
    s_mov_b64 exec, 15
    buffer_store_dword v46, v47, s[48:51], s64 offen sc1
    s_mov_b64 exec, -1
.pf_29:
    s_cmp_ge_u32 s63, 2
    s_cbranch_scc1 .wl_30
    v_mov_b32 v47, 152576
.wf_31:
    ds_read_b32 v46, v47
    s_waitcnt lgkmcnt(0)
    v_readfirstlane_b32 s63, v46
    s_nop 1
    s_cmp_ge_u32 s63, 2
    s_cbranch_scc1 .wfok_32
    s_add_u32 s47, s47, 1
    s_cmp_lt_u32 s47, 2000000
    s_cbranch_scc1 .wf_31
    s_branch .Lend
.wfok_32:
.wl_30:
    ds_read_b64_tr_b16 v[144:145], v24 offset:0
    ds_read_b64_tr_b16 v[146:147], v24 offset:16384
    ds_read_b64_tr_b16 v[148:149], v25 offset:0
    ds_read_b64_tr_b16 v[150:151], v25 offset:16384
    ds_read_b64_tr_b16 v[152:153], v26 offset:0
    ds_read_b64_tr_b16 v[154:155], v26 offset:16384
    ds_read_b64_tr_b16 v[156:157], v27 offset:0
    ds_read_b64_tr_b16 v[158:159], v27 offset:16384
    s_lshr_b32 s65, s62, 1
    s_cmp_lg_u32 s65, 0
    s_cbranch_scc1 .ps_33
    s_waitcnt lgkmcnt(0)
    ds_read_b128 v[80:83], v16 offset:0
    ds_read_b128 v[84:87], v17 offset:0
    ds_read_b128 v[88:91], v18 offset:0
    ds_read_b128 v[92:95], v19 offset:0
    ds_read_b128 v[96:99], v16 offset:256
    ds_read_b128 v[100:103], v17 offset:256
    ds_read_b128 v[104:107], v18 offset:256
    ds_read_b128 v[108:111], v19 offset:256
    ds_read_b128 v[112:115], v16 offset:512
    ds_read_b128 v[116:119], v17 offset:512
    ds_read_b128 v[120:123], v18 offset:512
    ds_read_b128 v[124:127], v19 offset:512
    s_waitcnt lgkmcnt(4)
    ds_read_b128 v[128:131], v16 offset:768
    ds_read_b128 v[132:135], v17 offset:768
    ds_read_b128 v[136:139], v18 offset:768
    ds_read_b128 v[140:143], v19 offset:768
.ps_33:
    s_waitcnt lgkmcnt(0)
    v_mov_b32 v47, 152636
    v_mov_b32 v46, 1
    s_mov_b64 exec, 1
    ds_add_u32 v47, v46
    s_mov_b64 exec, -1
    s_cmp_ge_u32 s63, 4
    s_cbranch_scc1 .wl_34
    v_mov_b32 v47, 152576
.wf_35:
    ds_read_b32 v46, v47
    s_waitcnt lgkmcnt(0)
    v_readfirstlane_b32 s63, v46
    s_nop 1
    s_cmp_ge_u32 s63, 4
    s_cbranch_scc1 .wfok_36
    s_add_u32 s47, s47, 1
    s_cmp_lt_u32 s47, 2000000
    s_cbranch_scc1 .wf_35
    s_branch .Lend
.wfok_36:
.wl_34:
    ds_read_b64_tr_b16 v[160:161], v24 offset:32768
    ds_read_b64_tr_b16 v[162:163], v24 offset:49152
    ds_read_b64_tr_b16 v[164:165], v25 offset:32768
    ds_read_b64_tr_b16 v[166:167], v25 offset:49152
    ds_read_b64_tr_b16 v[168:169], v26 offset:32768
    ds_read_b64_tr_b16 v[170:171], v26 offset:49152
    ds_read_b64_tr_b16 v[172:173], v27 offset:32768
    ds_read_b64_tr_b16 v[174:175], v27 offset:49152
    s_lshr_b32 s65, s62, 1
    s_cmp_lg_u32 s65, 1
    s_cbranch_scc1 .ps_37
    s_waitcnt lgkmcnt(0)
    ds_read_b128 v[80:83], v16 offset:0
    ds_read_b128 v[84:87], v17 offset:0
    ds_read_b128 v[88:91], v18 offset:0
    ds_read_b128 v[92:95], v19 offset:0
    ds_read_b128 v[96:99], v16 offset:256
    ds_read_b128 v[100:103], v17 offset:256
    ds_read_b128 v[104:107], v18 offset:256
    ds_read_b128 v[108:111], v19 offset:256
    ds_read_b128 v[112:115], v16 offset:512
    ds_read_b128 v[116:119], v17 offset:512
    ds_read_b128 v[120:123], v18 offset:512
    ds_read_b128 v[124:127], v19 offset:512
    s_waitcnt lgkmcnt(4)
    ds_read_b128 v[128:131], v16 offset:768
    ds_read_b128 v[132:135], v17 offset:768
    ds_read_b128 v[136:139], v18 offset:768
    ds_read_b128 v[140:143], v19 offset:768
.ps_37:
    s_waitcnt lgkmcnt(0)
    v_mov_b32 v47, 152640
    v_mov_b32 v46, 1
    s_mov_b64 exec, 1
    ds_add_u32 v47, v46
    s_mov_b64 exec, -1
    s_cmp_ge_u32 s63, 6
    s_cbranch_scc1 .wl_38
    v_mov_b32 v47, 152576
.wf_39:
    ds_read_b32 v46, v47
    s_waitcnt lgkmcnt(0)
    v_readfirstlane_b32 s63, v46
    s_nop 1
    s_cmp_ge_u32 s63, 6
    s_cbranch_scc1 .wfok_40
    s_add_u32 s47, s47, 1
    s_cmp_lt_u32 s47, 2000000
    s_cbranch_scc1 .wf_39
    s_branch .Lend
.wfok_40:
.wl_38:
    ds_read_b64_tr_b16 v[176:177], v28 offset:0
    ds_read_b64_tr_b16 v[178:179], v28 offset:16384
    ds_read_b64_tr_b16 v[180:181], v29 offset:0
    ds_read_b64_tr_b16 v[182:183], v29 offset:16384
    ds_read_b64_tr_b16 v[184:185], v30 offset:0
    ds_read_b64_tr_b16 v[186:187], v30 offset:16384
    ds_read_b64_tr_b16 v[188:189], v31 offset:0
    ds_read_b64_tr_b16 v[190:191], v31 offset:16384
    s_lshr_b32 s65, s62, 1
    s_cmp_lg_u32 s65, 2
    s_cbranch_scc1 .ps_41
    s_waitcnt lgkmcnt(0)
    ds_read_b128 v[80:83], v16 offset:0
    ds_read_b128 v[84:87], v17 offset:0
    ds_read_b128 v[88:91], v18 offset:0
    ds_read_b128 v[92:95], v19 offset:0
    ds_read_b128 v[96:99], v16 offset:256
    ds_read_b128 v[100:103], v17 offset:256
    ds_read_b128 v[104:107], v18 offset:256
    ds_read_b128 v[108:111], v19 offset:256
    ds_read_b128 v[112:115], v16 offset:512
    ds_read_b128 v[116:119], v17 offset:512
    ds_read_b128 v[120:123], v18 offset:512
    ds_read_b128 v[124:127], v19 offset:512
    s_waitcnt lgkmcnt(4)
    ds_read_b128 v[128:131], v16 offset:768
    ds_read_b128 v[132:135], v17 offset:768
    ds_read_b128 v[136:139], v18 offset:768
    ds_read_b128 v[140:143], v19 offset:768
.ps_41:
    s_waitcnt lgkmcnt(0)
    v_mov_b32 v47, 152644
    v_mov_b32 v46, 1
    s_mov_b64 exec, 1
    ds_add_u32 v47, v46
    s_mov_b64 exec, -1
    s_branch .Lattn_s
.Lw2:
    s_load_dword s44, s[42:43], 0
    s_lshl_b32 s72, s74, 23
    s_lshl_b32 s73, s75, 17
    s_add_u32 s72, s72, s73
    s_lshl_b32 s68, s76, 16
    s_xor_b32 s69, s68, 0x10000
    s_add_u32 s73, s72, s69
    s_add_u32 s72, s72, s68
    v_lshlrev_b32 v244, 4, v1

    v_xor_b32 v48, 0, v244
    v_xor_b32 v49, 16, v244
    v_xor_b32 v50, 128, v244
    v_xor_b32 v51, 144, v244
    v_xor_b32 v52, 32, v244
    v_xor_b32 v53, 48, v244
    v_xor_b32 v54, 160, v244
    v_xor_b32 v55, 176, v244
    v_xor_b32 v56, 64, v244
    v_xor_b32 v57, 80, v244
    v_xor_b32 v58, 192, v244
    v_xor_b32 v59, 208, v244
    v_xor_b32 v60, 96, v244
    v_xor_b32 v61, 112, v244
    v_xor_b32 v62, 224, v244
    v_xor_b32 v63, 240, v244
    v_mov_b32 v71, 152576
    v_mov_b32 v47, 152652
.wf_42:
    ds_read_b32 v46, v47
    s_waitcnt lgkmcnt(0)
    v_readfirstlane_b32 s65, v46
    s_nop 1
    s_cmp_ge_u32 s65, 1
    s_cbranch_scc1 .wfok_43
    s_add_u32 s47, s47, 1
    s_cmp_lt_u32 s47, 2000000
    s_cbranch_scc1 .wf_42
    s_branch .Lend
.wfok_43:
    s_mov_b32 s52, s18
    s_mov_b32 s53, s19
    s_mov_b32 s54, 16777216
    s_mov_b32 s55, 0x00020000
    s_mov_b32 m0, 0
    s_add_u32 s67, s72, 0
    buffer_load_dwordx4 v48, s[52:55], s67 offen nt lds
    s_mov_b32 m0, 1024
    s_add_u32 s67, s72, 1024
    buffer_load_dwordx4 v49, s[52:55], s67 offen nt lds
    s_mov_b32 m0, 2048
    s_add_u32 s67, s72, 2048
    buffer_load_dwordx4 v50, s[52:55], s67 offen nt lds
    s_mov_b32 m0, 3072
    s_add_u32 s67, s72, 3072
    buffer_load_dwordx4 v51, s[52:55], s67 offen nt lds
    s_mov_b32 m0, 4096
    s_add_u32 s67, s72, 4096
    buffer_load_dwordx4 v52, s[52:55], s67 offen nt lds
    s_mov_b32 m0, 5120
    s_add_u32 s67, s72, 5120
    buffer_load_dwordx4 v53, s[52:55], s67 offen nt lds
    s_mov_b32 m0, 6144
    s_add_u32 s67, s72, 6144
    buffer_load_dwordx4 v54, s[52:55], s67 offen nt lds
    s_mov_b32 m0, 7168
    s_add_u32 s67, s72, 7168
    buffer_load_dwordx4 v55, s[52:55], s67 offen nt lds
    s_mov_b32 m0, 8192
    s_add_u32 s67, s72, 8192
    buffer_load_dwordx4 v56, s[52:55], s67 offen nt lds
    s_mov_b32 m0, 9216
    s_add_u32 s67, s72, 9216
    buffer_load_dwordx4 v57, s[52:55], s67 offen nt lds
    s_mov_b32 m0, 10240
    s_add_u32 s67, s72, 10240
    buffer_load_dwordx4 v58, s[52:55], s67 offen nt lds
    s_mov_b32 m0, 11264
    s_add_u32 s67, s72, 11264
    buffer_load_dwordx4 v59, s[52:55], s67 offen nt lds
    s_mov_b32 m0, 12288
    s_add_u32 s67, s72, 12288
    buffer_load_dwordx4 v60, s[52:55], s67 offen nt lds
    s_mov_b32 m0, 13312
    s_add_u32 s67, s72, 13312
    buffer_load_dwordx4 v61, s[52:55], s67 offen nt lds
    s_mov_b32 m0, 14336
    s_add_u32 s67, s72, 14336
    buffer_load_dwordx4 v62, s[52:55], s67 offen nt lds
    s_mov_b32 m0, 15360
    s_add_u32 s67, s72, 15360
    buffer_load_dwordx4 v63, s[52:55], s67 offen nt lds
    v_mov_b32 v246, 16
    ds_write_b32 v71, v246 offset:40
    s_mov_b32 m0, 16384
    s_add_u32 s67, s73, 0
    buffer_load_dwordx4 v48, s[52:55], s67 offen nt lds
    s_mov_b32 m0, 17408
    s_add_u32 s67, s73, 1024
    buffer_load_dwordx4 v49, s[52:55], s67 offen nt lds
    s_mov_b32 m0, 18432
    s_add_u32 s67, s73, 2048
    buffer_load_dwordx4 v50, s[52:55], s67 offen nt lds
    s_mov_b32 m0, 19456
    s_add_u32 s67, s73, 3072
    buffer_load_dwordx4 v51, s[52:55], s67 offen nt lds
    s_mov_b32 m0, 20480
    s_add_u32 s67, s73, 4096
    buffer_load_dwordx4 v52, s[52:55], s67 offen nt lds
    s_mov_b32 m0, 21504
    s_add_u32 s67, s73, 5120
    buffer_load_dwordx4 v53, s[52:55], s67 offen nt lds
    s_mov_b32 m0, 22528
    s_add_u32 s67, s73, 6144
    buffer_load_dwordx4 v54, s[52:55], s67 offen nt lds
    s_mov_b32 m0, 23552
    s_add_u32 s67, s73, 7168
    buffer_load_dwordx4 v55, s[52:55], s67 offen nt lds
    v_and_b32 v32, 1, v2
    v_and_b32 v33, 2, v2
    v_lshl_or_b32 v32, v33, 2, v32
    v_lshrrev_b32 v33, 1, v2
    v_and_b32 v33, 6, v33
    v_or_b32 v32, v32, v33
    v_xor_b32 v32, v32, v3
    v_lshlrev_b32 v32, 4, v32
    v_lshl_add_u32 v32, v2, 10, v32
    s_lshl_b32 s64, s62, 14

    v_xor_b32 v20, 0, v32
    v_xor_b32 v21, 64, v32
    v_xor_b32 v22, 128, v32
    v_xor_b32 v23, 192, v32
    v_add_u32 v16, s64, v20
    v_add_u32 v20, 131072, v20
    v_add_u32 v17, s64, v21
    v_add_u32 v21, 131072, v21
    v_add_u32 v18, s64, v22
    v_add_u32 v22, 131072, v22
    v_add_u32 v19, s64, v23
    v_add_u32 v23, 131072, v23
    v_lshrrev_b32 v32, 2, v1
    v_and_b32 v33, 1, v32
    v_and_b32 v34, 2, v32
    v_lshl_or_b32 v33, v34, 2, v33
    v_lshrrev_b32 v34, 1, v32
    v_and_b32 v34, 6, v34
    v_or_b32 v33, v33, v34
    v_and_b32 v34, 3, v1
    v_lshlrev_b32 v35, 1, v34
    s_and_b32 s65, s62, 1
    s_lshl_b32 s65, s65, 3
    v_or_b32 v35, s65, v35
    v_xor_b32 v35, v35, v33
    v_lshlrev_b32 v35, 4, v35
    v_lshl_add_u32 v35, v32, 10, v35
    s_lshr_b32 s65, s62, 1
    s_lshl_b32 s65, s65, 8
    v_add_u32 v35, s65, v35
    v_and_b32 v34, 1, v34
    v_lshl_or_b32 v35, v34, 3, v35

    v_xor_b32 v24, 0, v35
    v_add_u32 v28, 0x10000, v24
    v_xor_b32 v25, 8, v35
    v_add_u32 v29, 0x10000, v25
    v_xor_b32 v26, 16, v35
    v_add_u32 v30, 0x10000, v26
    v_xor_b32 v27, 24, v35
    v_add_u32 v31, 0x10000, v27
    s_lshr_b32 s68, s2, 7
    s_lshl_b32 s68, s68, 3
    s_and_b32 s65, s2, 7
    s_add_u32 s68, s68, s65
    s_lshl_b32 s68, s68, 13
    s_bfe_u32 s65, s2, 0x40003
    s_lshl_b32 s65, s65, 7
    s_add_u32 s68, s68, s65
    s_add_u32 s68, s68, 6144
    s_lshl_b32 s77, s68, 8
    s_lshl_b32 s78, s46, 19
    s_lshl_b32 s65, s45, 8
    s_add_u32 s78, s78, s65
    s_lshl_b32 s79, s45, 17
    s_lshr_b32 s65, s46, 2
    s_lshl_b32 s65, s65, 16
    s_add_u32 s79, s79, s65
    s_and_b32 s65, s46, 3
    s_lshl_b32 s65, s65, 8
    s_add_u32 s79, s79, s65
    v_and_b32 v32, 1, v3
    v_and_b32 v33, 2, v3
    v_lshl_or_b32 v32, v33, 2, v32
    v_xor_b32 v32, v32, v2
    v_lshlrev_b32 v32, 4, v32
    v_lshl_add_u32 v32, v3, 8, v32

    v_xor_b32 v64, 0, v32
    v_xor_b32 v65, 32, v32
    v_xor_b32 v66, 64, v32
    v_xor_b32 v67, 96, v32
    v_lshlrev_b32 v68, 4, v1
    v_lshlrev_b32 v69, 17, v3
    v_lshl_add_u32 v69, v2, 4, v69
    v_lshlrev_b32 v70, 14, v3
    v_lshl_add_u32 v70, v2, 4, v70

    s_waitcnt vmcnt(23)
    s_mov_b32 m0, 24576
    s_add_u32 s67, s73, 8192
    buffer_load_dwordx4 v56, s[52:55], s67 offen nt lds
    s_waitcnt vmcnt(23)
    s_mov_b32 m0, 25600
    s_add_u32 s67, s73, 9216
    buffer_load_dwordx4 v57, s[52:55], s67 offen nt lds
    s_waitcnt vmcnt(23)
    s_mov_b32 m0, 26624
    s_add_u32 s67, s73, 10240
    buffer_load_dwordx4 v58, s[52:55], s67 offen nt lds
    s_waitcnt vmcnt(23)
    s_mov_b32 m0, 27648
    s_add_u32 s67, s73, 11264
    buffer_load_dwordx4 v59, s[52:55], s67 offen nt lds
    s_waitcnt vmcnt(23)
    s_mov_b32 m0, 28672
    s_add_u32 s67, s73, 12288
    buffer_load_dwordx4 v60, s[52:55], s67 offen nt lds
    s_waitcnt vmcnt(23)
    s_mov_b32 m0, 29696
    s_add_u32 s67, s73, 13312
    buffer_load_dwordx4 v61, s[52:55], s67 offen nt lds
    s_waitcnt vmcnt(23)
    s_mov_b32 m0, 30720
    s_add_u32 s67, s73, 14336
    buffer_load_dwordx4 v62, s[52:55], s67 offen nt lds
    s_waitcnt vmcnt(23)
    s_mov_b32 m0, 31744
    s_add_u32 s67, s73, 15360
    buffer_load_dwordx4 v63, s[52:55], s67 offen nt lds
    v_mov_b32 v246, 32
    ds_write_b32 v71, v246 offset:40
    s_waitcnt vmcnt(23)
    s_mov_b32 m0, 32768
    s_add_u32 s67, s72, 16384
    buffer_load_dwordx4 v48, s[52:55], s67 offen nt lds
    s_waitcnt vmcnt(23)
    s_mov_b32 m0, 33792
    s_add_u32 s67, s72, 17408
    buffer_load_dwordx4 v49, s[52:55], s67 offen nt lds
    s_waitcnt vmcnt(23)
    s_mov_b32 m0, 34816
    s_add_u32 s67, s72, 18432
    buffer_load_dwordx4 v50, s[52:55], s67 offen nt lds
    s_waitcnt vmcnt(23)
    s_mov_b32 m0, 35840
    s_add_u32 s67, s72, 19456
    buffer_load_dwordx4 v51, s[52:55], s67 offen nt lds
    s_waitcnt vmcnt(23)
    s_mov_b32 m0, 36864
    s_add_u32 s67, s72, 20480
    buffer_load_dwordx4 v52, s[52:55], s67 offen nt lds
    s_waitcnt vmcnt(23)
    s_mov_b32 m0, 37888
    s_add_u32 s67, s72, 21504
    buffer_load_dwordx4 v53, s[52:55], s67 offen nt lds
    s_waitcnt vmcnt(23)
    s_mov_b32 m0, 38912
    s_add_u32 s67, s72, 22528
    buffer_load_dwordx4 v54, s[52:55], s67 offen nt lds
    s_waitcnt vmcnt(23)
    v_mov_b32 v246, 1
    ds_write_b32 v71, v246 offset:0
    s_mov_b32 m0, 39936
    s_add_u32 s67, s72, 23552
    buffer_load_dwordx4 v55, s[52:55], s67 offen nt lds
    s_waitcnt vmcnt(23)
    s_mov_b32 m0, 40960
    s_add_u32 s67, s72, 24576
    buffer_load_dwordx4 v56, s[52:55], s67 offen nt lds
    s_waitcnt vmcnt(23)
    s_mov_b32 m0, 41984
    s_add_u32 s67, s72, 25600
    buffer_load_dwordx4 v57, s[52:55], s67 offen nt lds
    s_waitcnt vmcnt(23)
    s_mov_b32 m0, 43008
    s_add_u32 s67, s72, 26624
    buffer_load_dwordx4 v58, s[52:55], s67 offen nt lds
    s_waitcnt vmcnt(23)
    s_mov_b32 m0, 44032
    s_add_u32 s67, s72, 27648
    buffer_load_dwordx4 v59, s[52:55], s67 offen nt lds
    s_waitcnt vmcnt(23)
    s_mov_b32 m0, 45056
    s_add_u32 s67, s72, 28672
    buffer_load_dwordx4 v60, s[52:55], s67 offen nt lds
    s_waitcnt vmcnt(23)
    s_mov_b32 m0, 46080
    s_add_u32 s67, s72, 29696
    buffer_load_dwordx4 v61, s[52:55], s67 offen nt lds
    s_waitcnt vmcnt(23)
    s_mov_b32 m0, 47104
    s_add_u32 s67, s72, 30720
    buffer_load_dwordx4 v62, s[52:55], s67 offen nt lds
    s_waitcnt vmcnt(23)
    s_mov_b32 m0, 48128
    s_add_u32 s67, s72, 31744
    buffer_load_dwordx4 v63, s[52:55], s67 offen nt lds
    v_mov_b32 v246, 48
    ds_write_b32 v71, v246 offset:40
    s_waitcnt vmcnt(23)
    s_mov_b32 m0, 49152
    s_add_u32 s67, s73, 16384
    buffer_load_dwordx4 v48, s[52:55], s67 offen nt lds
    s_waitcnt vmcnt(23)
    s_mov_b32 m0, 50176
    s_add_u32 s67, s73, 17408
    buffer_load_dwordx4 v49, s[52:55], s67 offen nt lds
    s_waitcnt vmcnt(23)
    s_mov_b32 m0, 51200
    s_add_u32 s67, s73, 18432
    buffer_load_dwordx4 v50, s[52:55], s67 offen nt lds
    s_waitcnt vmcnt(23)
    s_mov_b32 m0, 52224
    s_add_u32 s67, s73, 19456
    buffer_load_dwordx4 v51, s[52:55], s67 offen nt lds
    s_waitcnt vmcnt(23)
    s_mov_b32 m0, 53248
    s_add_u32 s67, s73, 20480
    buffer_load_dwordx4 v52, s[52:55], s67 offen nt lds
    s_waitcnt vmcnt(23)
    s_mov_b32 m0, 54272
    s_add_u32 s67, s73, 21504
    buffer_load_dwordx4 v53, s[52:55], s67 offen nt lds
    s_waitcnt vmcnt(23)
    s_mov_b32 m0, 55296
    s_add_u32 s67, s73, 22528
    buffer_load_dwordx4 v54, s[52:55], s67 offen nt lds
    s_waitcnt vmcnt(23)
    v_mov_b32 v246, 2
    ds_write_b32 v71, v246 offset:0
    ds_read_b64_tr_b16 v[144:145], v24 offset:0
    ds_read_b64_tr_b16 v[146:147], v24 offset:16384
    ds_read_b64_tr_b16 v[148:149], v25 offset:0
    ds_read_b64_tr_b16 v[150:151], v25 offset:16384
    ds_read_b64_tr_b16 v[152:153], v26 offset:0
    ds_read_b64_tr_b16 v[154:155], v26 offset:16384
    ds_read_b64_tr_b16 v[156:157], v27 offset:0
    ds_read_b64_tr_b16 v[158:159], v27 offset:16384
    s_waitcnt lgkmcnt(0)
    ds_read_b128 v[80:83], v16 offset:0
    ds_read_b128 v[84:87], v17 offset:0
    ds_read_b128 v[88:91], v18 offset:0
    ds_read_b128 v[92:95], v19 offset:0
    ds_read_b128 v[96:99], v16 offset:256
    ds_read_b128 v[100:103], v17 offset:256
    ds_read_b128 v[104:107], v18 offset:256
    ds_read_b128 v[108:111], v19 offset:256
    ds_read_b128 v[112:115], v16 offset:512
    ds_read_b128 v[116:119], v17 offset:512
    ds_read_b128 v[120:123], v18 offset:512
    ds_read_b128 v[124:127], v19 offset:512
    s_waitcnt lgkmcnt(4)
    ds_read_b128 v[128:131], v16 offset:768
    ds_read_b128 v[132:135], v17 offset:768
    ds_read_b128 v[136:139], v18 offset:768
    ds_read_b128 v[140:143], v19 offset:768
    s_waitcnt lgkmcnt(0)
    v_mov_b32 v47, 152636
    v_mov_b32 v46, 1
    s_mov_b64 exec, 1
    ds_add_u32 v47, v46
    s_mov_b64 exec, -1
    s_mov_b32 m0, 56320
    s_add_u32 s67, s73, 23552
    buffer_load_dwordx4 v55, s[52:55], s67 offen nt lds
    s_waitcnt vmcnt(23)
    s_mov_b32 m0, 57344
    s_add_u32 s67, s73, 24576
    buffer_load_dwordx4 v56, s[52:55], s67 offen nt lds
    s_waitcnt vmcnt(23)
    s_mov_b32 m0, 58368
    s_add_u32 s67, s73, 25600
    buffer_load_dwordx4 v57, s[52:55], s67 offen nt lds
    s_waitcnt vmcnt(23)
    s_mov_b32 m0, 59392
    s_add_u32 s67, s73, 26624
    buffer_load_dwordx4 v58, s[52:55], s67 offen nt lds
    s_waitcnt vmcnt(23)
    s_mov_b32 m0, 60416
    s_add_u32 s67, s73, 27648
    buffer_load_dwordx4 v59, s[52:55], s67 offen nt lds
    s_waitcnt vmcnt(23)
    s_mov_b32 m0, 61440
    s_add_u32 s67, s73, 28672
    buffer_load_dwordx4 v60, s[52:55], s67 offen nt lds
    s_waitcnt vmcnt(23)
    s_mov_b32 m0, 62464
    s_add_u32 s67, s73, 29696
    buffer_load_dwordx4 v61, s[52:55], s67 offen nt lds
    s_waitcnt vmcnt(23)
    s_mov_b32 m0, 63488
    s_add_u32 s67, s73, 30720
    buffer_load_dwordx4 v62, s[52:55], s67 offen nt lds
    s_waitcnt vmcnt(23)
    s_mov_b32 m0, 64512
    s_add_u32 s67, s73, 31744
    buffer_load_dwordx4 v63, s[52:55], s67 offen nt lds
    v_mov_b32 v246, 64
    ds_write_b32 v71, v246 offset:40
    s_waitcnt vmcnt(23)
    s_mov_b32 m0, 65536
    s_add_u32 s67, s72, 32768
    buffer_load_dwordx4 v48, s[52:55], s67 offen nt lds
    s_waitcnt vmcnt(23)
    s_mov_b32 m0, 66560
    s_add_u32 s67, s72, 33792
    buffer_load_dwordx4 v49, s[52:55], s67 offen nt lds
    s_waitcnt vmcnt(23)
    s_mov_b32 m0, 67584
    s_add_u32 s67, s72, 34816
    buffer_load_dwordx4 v50, s[52:55], s67 offen nt lds
    s_waitcnt vmcnt(23)
    s_mov_b32 m0, 68608
    s_add_u32 s67, s72, 35840
    buffer_load_dwordx4 v51, s[52:55], s67 offen nt lds
    s_waitcnt vmcnt(23)
    s_mov_b32 m0, 69632
    s_add_u32 s67, s72, 36864
    buffer_load_dwordx4 v52, s[52:55], s67 offen nt lds
    s_waitcnt vmcnt(23)
    s_mov_b32 m0, 70656
    s_add_u32 s67, s72, 37888
    buffer_load_dwordx4 v53, s[52:55], s67 offen nt lds
    s_waitcnt vmcnt(23)
    s_mov_b32 m0, 71680
    s_add_u32 s67, s72, 38912
    buffer_load_dwordx4 v54, s[52:55], s67 offen nt lds
    s_waitcnt vmcnt(23)
    v_mov_b32 v246, 3
    ds_write_b32 v71, v246 offset:0
    s_mov_b32 m0, 72704
    s_add_u32 s67, s72, 39936
    buffer_load_dwordx4 v55, s[52:55], s67 offen nt lds
    s_waitcnt vmcnt(23)
    s_mov_b32 m0, 73728
    s_add_u32 s67, s72, 40960
    buffer_load_dwordx4 v56, s[52:55], s67 offen nt lds
    s_waitcnt vmcnt(23)
    s_mov_b32 m0, 74752
    s_add_u32 s67, s72, 41984
    buffer_load_dwordx4 v57, s[52:55], s67 offen nt lds
    s_waitcnt vmcnt(23)
    s_mov_b32 m0, 75776
    s_add_u32 s67, s72, 43008
    buffer_load_dwordx4 v58, s[52:55], s67 offen nt lds
    s_waitcnt vmcnt(23)
    s_mov_b32 m0, 76800
    s_add_u32 s67, s72, 44032
    buffer_load_dwordx4 v59, s[52:55], s67 offen nt lds
    s_waitcnt vmcnt(23)
    s_mov_b32 m0, 77824
    s_add_u32 s67, s72, 45056
    buffer_load_dwordx4 v60, s[52:55], s67 offen nt lds
    s_waitcnt vmcnt(23)
    s_mov_b32 m0, 78848
    s_add_u32 s67, s72, 46080
    buffer_load_dwordx4 v61, s[52:55], s67 offen nt lds
    s_waitcnt vmcnt(23)
    s_mov_b32 m0, 79872
    s_add_u32 s67, s72, 47104
    buffer_load_dwordx4 v62, s[52:55], s67 offen nt lds
    s_waitcnt vmcnt(23)
    s_mov_b32 m0, 80896
    s_add_u32 s67, s72, 48128
    buffer_load_dwordx4 v63, s[52:55], s67 offen nt lds
    v_mov_b32 v246, 80
    ds_write_b32 v71, v246 offset:40
    s_waitcnt vmcnt(23)
    s_mov_b32 m0, 81920
    s_add_u32 s67, s73, 32768
    buffer_load_dwordx4 v48, s[52:55], s67 offen nt lds
    s_waitcnt vmcnt(23)
    s_mov_b32 m0, 82944
    s_add_u32 s67, s73, 33792
    buffer_load_dwordx4 v49, s[52:55], s67 offen nt lds
    s_waitcnt vmcnt(23)
    s_mov_b32 m0, 83968
    s_add_u32 s67, s73, 34816
    buffer_load_dwordx4 v50, s[52:55], s67 offen nt lds
    s_waitcnt vmcnt(23)
    s_mov_b32 m0, 84992
    s_add_u32 s67, s73, 35840
    buffer_load_dwordx4 v51, s[52:55], s67 offen nt lds
    s_waitcnt vmcnt(23)
    s_mov_b32 m0, 86016
    s_add_u32 s67, s73, 36864
    buffer_load_dwordx4 v52, s[52:55], s67 offen nt lds
    s_waitcnt vmcnt(23)
    s_mov_b32 m0, 87040
    s_add_u32 s67, s73, 37888
    buffer_load_dwordx4 v53, s[52:55], s67 offen nt lds
    s_waitcnt vmcnt(23)
    s_mov_b32 m0, 88064
    s_add_u32 s67, s73, 38912
    buffer_load_dwordx4 v54, s[52:55], s67 offen nt lds
    s_waitcnt vmcnt(23)
    v_mov_b32 v246, 4
    ds_write_b32 v71, v246 offset:0
    ds_read_b64_tr_b16 v[160:161], v24 offset:32768
    ds_read_b64_tr_b16 v[162:163], v24 offset:49152
    ds_read_b64_tr_b16 v[164:165], v25 offset:32768
    ds_read_b64_tr_b16 v[166:167], v25 offset:49152
    ds_read_b64_tr_b16 v[168:169], v26 offset:32768
    ds_read_b64_tr_b16 v[170:171], v26 offset:49152
    ds_read_b64_tr_b16 v[172:173], v27 offset:32768
    ds_read_b64_tr_b16 v[174:175], v27 offset:49152
    s_waitcnt lgkmcnt(0)
    v_mov_b32 v47, 152640
    v_mov_b32 v46, 1
    s_mov_b64 exec, 1
    ds_add_u32 v47, v46
    s_mov_b64 exec, -1
    s_mov_b32 m0, 89088
    s_add_u32 s67, s73, 39936
    buffer_load_dwordx4 v55, s[52:55], s67 offen nt lds
    s_waitcnt vmcnt(23)
    s_mov_b32 m0, 90112
    s_add_u32 s67, s73, 40960
    buffer_load_dwordx4 v56, s[52:55], s67 offen nt lds
    s_waitcnt vmcnt(23)
    s_mov_b32 m0, 91136
    s_add_u32 s67, s73, 41984
    buffer_load_dwordx4 v57, s[52:55], s67 offen nt lds
    s_waitcnt vmcnt(23)
    s_mov_b32 m0, 92160
    s_add_u32 s67, s73, 43008
    buffer_load_dwordx4 v58, s[52:55], s67 offen nt lds
    s_waitcnt vmcnt(23)
    s_mov_b32 m0, 93184
    s_add_u32 s67, s73, 44032
    buffer_load_dwordx4 v59, s[52:55], s67 offen nt lds
    s_waitcnt vmcnt(23)
    s_mov_b32 m0, 94208
    s_add_u32 s67, s73, 45056
    buffer_load_dwordx4 v60, s[52:55], s67 offen nt lds
    s_waitcnt vmcnt(23)
    s_mov_b32 m0, 95232
    s_add_u32 s67, s73, 46080
    buffer_load_dwordx4 v61, s[52:55], s67 offen nt lds
    s_waitcnt vmcnt(23)
    s_mov_b32 m0, 96256
    s_add_u32 s67, s73, 47104
    buffer_load_dwordx4 v62, s[52:55], s67 offen nt lds
    s_waitcnt vmcnt(23)
    s_mov_b32 m0, 97280
    s_add_u32 s67, s73, 48128
    buffer_load_dwordx4 v63, s[52:55], s67 offen nt lds
    v_mov_b32 v246, 96
    ds_write_b32 v71, v246 offset:40
    s_waitcnt vmcnt(23)
    s_mov_b32 m0, 98304
    s_add_u32 s67, s72, 49152
    buffer_load_dwordx4 v48, s[52:55], s67 offen nt lds
    s_waitcnt vmcnt(23)
    s_mov_b32 m0, 99328
    s_add_u32 s67, s72, 50176
    buffer_load_dwordx4 v49, s[52:55], s67 offen nt lds
    s_waitcnt vmcnt(23)
    s_mov_b32 m0, 100352
    s_add_u32 s67, s72, 51200
    buffer_load_dwordx4 v50, s[52:55], s67 offen nt lds
    s_waitcnt vmcnt(23)
    s_mov_b32 m0, 101376
    s_add_u32 s67, s72, 52224
    buffer_load_dwordx4 v51, s[52:55], s67 offen nt lds
    s_waitcnt vmcnt(23)
    s_mov_b32 m0, 102400
    s_add_u32 s67, s72, 53248
    buffer_load_dwordx4 v52, s[52:55], s67 offen nt lds
    s_waitcnt vmcnt(23)
    s_mov_b32 m0, 103424
    s_add_u32 s67, s72, 54272
    buffer_load_dwordx4 v53, s[52:55], s67 offen nt lds
    s_waitcnt vmcnt(23)
    s_mov_b32 m0, 104448
    s_add_u32 s67, s72, 55296
    buffer_load_dwordx4 v54, s[52:55], s67 offen nt lds
    s_waitcnt vmcnt(23)
    v_mov_b32 v246, 5
    ds_write_b32 v71, v246 offset:0
    s_mov_b32 m0, 105472
    s_add_u32 s67, s72, 56320
    buffer_load_dwordx4 v55, s[52:55], s67 offen nt lds
    s_waitcnt vmcnt(23)
    s_mov_b32 m0, 106496
    s_add_u32 s67, s72, 57344
    buffer_load_dwordx4 v56, s[52:55], s67 offen nt lds
    s_waitcnt vmcnt(23)
    s_mov_b32 m0, 107520
    s_add_u32 s67, s72, 58368
    buffer_load_dwordx4 v57, s[52:55], s67 offen nt lds
    s_waitcnt vmcnt(23)
    s_mov_b32 m0, 108544
    s_add_u32 s67, s72, 59392
    buffer_load_dwordx4 v58, s[52:55], s67 offen nt lds
    s_waitcnt vmcnt(23)
    s_mov_b32 m0, 109568
    s_add_u32 s67, s72, 60416
    buffer_load_dwordx4 v59, s[52:55], s67 offen nt lds
    s_waitcnt vmcnt(23)
    s_mov_b32 m0, 110592
    s_add_u32 s67, s72, 61440
    buffer_load_dwordx4 v60, s[52:55], s67 offen nt lds
    s_waitcnt vmcnt(23)
    s_mov_b32 m0, 111616
    s_add_u32 s67, s72, 62464
    buffer_load_dwordx4 v61, s[52:55], s67 offen nt lds
    s_waitcnt vmcnt(23)
    s_mov_b32 m0, 112640
    s_add_u32 s67, s72, 63488
    buffer_load_dwordx4 v62, s[52:55], s67 offen nt lds
    s_waitcnt vmcnt(23)
    s_mov_b32 m0, 113664
    s_add_u32 s67, s72, 64512
    buffer_load_dwordx4 v63, s[52:55], s67 offen nt lds
    v_mov_b32 v246, 112
    ds_write_b32 v71, v246 offset:40
    s_waitcnt vmcnt(23)
    s_mov_b32 m0, 114688
    s_add_u32 s67, s73, 49152
    buffer_load_dwordx4 v48, s[52:55], s67 offen nt lds
    s_waitcnt vmcnt(23)
    s_mov_b32 m0, 115712
    s_add_u32 s67, s73, 50176
    buffer_load_dwordx4 v49, s[52:55], s67 offen nt lds
    s_waitcnt vmcnt(23)
    s_mov_b32 m0, 116736
    s_add_u32 s67, s73, 51200
    buffer_load_dwordx4 v50, s[52:55], s67 offen nt lds
    s_waitcnt vmcnt(23)
    s_mov_b32 m0, 117760
    s_add_u32 s67, s73, 52224
    buffer_load_dwordx4 v51, s[52:55], s67 offen nt lds
    s_waitcnt vmcnt(23)
    s_mov_b32 m0, 118784
    s_add_u32 s67, s73, 53248
    buffer_load_dwordx4 v52, s[52:55], s67 offen nt lds
    s_waitcnt vmcnt(23)
    s_mov_b32 m0, 119808
    s_add_u32 s67, s73, 54272
    buffer_load_dwordx4 v53, s[52:55], s67 offen nt lds
    s_waitcnt vmcnt(23)
    s_mov_b32 m0, 120832
    s_add_u32 s67, s73, 55296
    buffer_load_dwordx4 v54, s[52:55], s67 offen nt lds
    s_waitcnt vmcnt(23)
    v_mov_b32 v246, 6
    ds_write_b32 v71, v246 offset:0
    ds_read_b64_tr_b16 v[176:177], v28 offset:0
    ds_read_b64_tr_b16 v[178:179], v28 offset:16384
    ds_read_b64_tr_b16 v[180:181], v29 offset:0
    ds_read_b64_tr_b16 v[182:183], v29 offset:16384
    ds_read_b64_tr_b16 v[184:185], v30 offset:0
    ds_read_b64_tr_b16 v[186:187], v30 offset:16384
    ds_read_b64_tr_b16 v[188:189], v31 offset:0
    ds_read_b64_tr_b16 v[190:191], v31 offset:16384
    s_waitcnt lgkmcnt(0)
    v_mov_b32 v47, 152644
    v_mov_b32 v46, 1
    s_mov_b64 exec, 1
    ds_add_u32 v47, v46
    s_mov_b64 exec, -1
    s_mov_b32 m0, 121856
    s_add_u32 s67, s73, 56320
    buffer_load_dwordx4 v55, s[52:55], s67 offen nt lds
    s_waitcnt vmcnt(23)
    s_mov_b32 m0, 122880
    s_add_u32 s67, s73, 57344
    buffer_load_dwordx4 v56, s[52:55], s67 offen nt lds
    s_waitcnt vmcnt(23)
    s_mov_b32 m0, 123904
    s_add_u32 s67, s73, 58368
    buffer_load_dwordx4 v57, s[52:55], s67 offen nt lds
    s_waitcnt vmcnt(23)
    s_mov_b32 m0, 124928
    s_add_u32 s67, s73, 59392
    buffer_load_dwordx4 v58, s[52:55], s67 offen nt lds
    s_waitcnt vmcnt(23)
    s_mov_b32 m0, 125952
    s_add_u32 s67, s73, 60416
    buffer_load_dwordx4 v59, s[52:55], s67 offen nt lds
    s_waitcnt vmcnt(23)
    s_mov_b32 m0, 126976
    s_add_u32 s67, s73, 61440
    buffer_load_dwordx4 v60, s[52:55], s67 offen nt lds
    s_waitcnt vmcnt(23)
    s_mov_b32 m0, 128000
    s_add_u32 s67, s73, 62464
    buffer_load_dwordx4 v61, s[52:55], s67 offen nt lds
    s_waitcnt vmcnt(23)
    s_mov_b32 m0, 129024
    s_add_u32 s67, s73, 63488
    buffer_load_dwordx4 v62, s[52:55], s67 offen nt lds
    s_waitcnt vmcnt(23)
    s_mov_b32 m0, 130048
    s_add_u32 s67, s73, 64512
    buffer_load_dwordx4 v63, s[52:55], s67 offen nt lds
    v_mov_b32 v246, 128
    ds_write_b32 v71, v246 offset:40
    s_waitcnt vmcnt(0)
    v_mov_b32 v246, 7
    ds_write_b32 v71, v246 offset:0
    v_mov_b32 v246, 8
    ds_write_b32 v71, v246 offset:0
    s_waitcnt lgkmcnt(0)
    s_add_u32 s44, s44, 2654435769
    s_mov_b32 s63, 8
    v_mov_b32 v47, 152632
.wf_44:
    ds_read_b32 v46, v47
    s_waitcnt lgkmcnt(0)
    v_readfirstlane_b32 s65, v46
    s_nop 1
    s_cmp_ge_u32 s65, 2
    s_cbranch_scc1 .wfok_45
    s_add_u32 s47, s47, 1
    s_cmp_lt_u32 s47, 2000000
    s_cbranch_scc1 .wf_44
    s_branch .Lend
.wfok_45:
    v_mov_b32 v47, 152636
.wf_46:
    ds_read_b32 v46, v47
    s_waitcnt lgkmcnt(0)
    v_readfirstlane_b32 s65, v46
    s_nop 1
    s_cmp_ge_u32 s65, 8
    s_cbranch_scc1 .wfok_47
    s_add_u32 s47, s47, 1
    s_cmp_lt_u32 s47, 2000000
    s_cbranch_scc1 .wf_46
    s_branch .Lend
.wfok_47:
    s_mov_b32 s52, s30
    s_mov_b32 s53, s31
    s_mov_b32 s54, 33554432
    s_mov_b32 s55, 0x00020000
    s_mov_b32 m0, 0
    s_add_u32 s67, s77, 0
    buffer_load_dwordx4 v64, s[52:55], s67 offen nt lds
    s_mov_b32 m0, 1024
    s_add_u32 s67, s77, 1024
    buffer_load_dwordx4 v65, s[52:55], s67 offen nt lds
    s_mov_b32 m0, 2048
    s_add_u32 s67, s77, 2048
    buffer_load_dwordx4 v66, s[52:55], s67 offen nt lds
    s_mov_b32 m0, 3072
    s_add_u32 s67, s77, 3072
    buffer_load_dwordx4 v67, s[52:55], s67 offen nt lds
    s_mov_b32 m0, 4096
    s_add_u32 s67, s77, 4096
    buffer_load_dwordx4 v64, s[52:55], s67 offen nt lds
    s_mov_b32 m0, 5120
    s_add_u32 s67, s77, 5120
    buffer_load_dwordx4 v65, s[52:55], s67 offen nt lds
    s_mov_b32 m0, 6144
    s_add_u32 s67, s77, 6144
    buffer_load_dwordx4 v66, s[52:55], s67 offen nt lds
    s_mov_b32 m0, 7168
    s_add_u32 s67, s77, 7168
    buffer_load_dwordx4 v67, s[52:55], s67 offen nt lds
    s_mov_b32 m0, 8192
    s_add_u32 s67, s77, 8192
    buffer_load_dwordx4 v64, s[52:55], s67 offen nt lds
    s_mov_b32 m0, 9216
    s_add_u32 s67, s77, 9216
    buffer_load_dwordx4 v65, s[52:55], s67 offen nt lds
    s_mov_b32 m0, 10240
    s_add_u32 s67, s77, 10240
    buffer_load_dwordx4 v66, s[52:55], s67 offen nt lds
    s_mov_b32 m0, 11264
    s_add_u32 s67, s77, 11264
    buffer_load_dwordx4 v67, s[52:55], s67 offen nt lds
    s_mov_b32 m0, 12288
    s_add_u32 s67, s77, 12288
    buffer_load_dwordx4 v64, s[52:55], s67 offen nt lds
    s_mov_b32 m0, 13312
    s_add_u32 s67, s77, 13312
    buffer_load_dwordx4 v65, s[52:55], s67 offen nt lds
    s_mov_b32 m0, 14336
    s_add_u32 s67, s77, 14336
    buffer_load_dwordx4 v66, s[52:55], s67 offen nt lds
    s_mov_b32 m0, 15360
    s_add_u32 s67, s77, 15360
    buffer_load_dwordx4 v67, s[52:55], s67 offen nt lds
    s_mov_b32 m0, 16384
    s_add_u32 s67, s77, 16384
    buffer_load_dwordx4 v64, s[52:55], s67 offen nt lds
    s_mov_b32 m0, 17408
    s_add_u32 s67, s77, 17408
    buffer_load_dwordx4 v65, s[52:55], s67 offen nt lds
    s_mov_b32 m0, 18432
    s_add_u32 s67, s77, 18432
    buffer_load_dwordx4 v66, s[52:55], s67 offen nt lds
    s_mov_b32 m0, 19456
    s_add_u32 s67, s77, 19456
    buffer_load_dwordx4 v67, s[52:55], s67 offen nt lds
    s_mov_b32 m0, 20480
    s_add_u32 s67, s77, 20480
    buffer_load_dwordx4 v64, s[52:55], s67 offen nt lds
    s_mov_b32 m0, 21504
    s_add_u32 s67, s77, 21504
    buffer_load_dwordx4 v65, s[52:55], s67 offen nt lds
    s_mov_b32 m0, 22528
    s_add_u32 s67, s77, 22528
    buffer_load_dwordx4 v66, s[52:55], s67 offen nt lds
    s_mov_b32 m0, 23552
    s_add_u32 s67, s77, 23552
    buffer_load_dwordx4 v67, s[52:55], s67 offen nt lds
    s_mov_b32 m0, 24576
    s_add_u32 s67, s77, 24576
    buffer_load_dwordx4 v64, s[52:55], s67 offen nt lds
    s_mov_b32 m0, 25600
    s_add_u32 s67, s77, 25600
    buffer_load_dwordx4 v65, s[52:55], s67 offen nt lds
    s_mov_b32 m0, 26624
    s_add_u32 s67, s77, 26624
    buffer_load_dwordx4 v66, s[52:55], s67 offen nt lds
    s_mov_b32 m0, 27648
    s_add_u32 s67, s77, 27648
    buffer_load_dwordx4 v67, s[52:55], s67 offen nt lds
    s_mov_b32 m0, 28672
    s_add_u32 s67, s77, 28672
    buffer_load_dwordx4 v64, s[52:55], s67 offen nt lds
    s_mov_b32 m0, 29696
    s_add_u32 s67, s77, 29696
    buffer_load_dwordx4 v65, s[52:55], s67 offen nt lds
    s_mov_b32 m0, 30720
    s_add_u32 s67, s77, 30720
    buffer_load_dwordx4 v66, s[52:55], s67 offen nt lds
    s_mov_b32 m0, 31744
    s_add_u32 s67, s77, 31744
    buffer_load_dwordx4 v67, s[52:55], s67 offen nt lds
    v_mov_b32 v47, 152640
.wf_48:
    ds_read_b32 v46, v47
    s_waitcnt lgkmcnt(0)
    v_readfirstlane_b32 s65, v46
    s_nop 1
    s_cmp_ge_u32 s65, 8
    s_cbranch_scc1 .wfok_49
    s_add_u32 s47, s47, 1
    s_cmp_lt_u32 s47, 2000000
    s_cbranch_scc1 .wf_48
    s_branch .Lend
.wfok_49:
    s_mov_b32 s52, s32
    s_mov_b32 s53, s33
    s_mov_b32 s54, 33554432
    s_mov_b32 s55, 0x00020000
    s_mov_b32 m0, 32768
    s_add_u32 s67, s77, 0
    buffer_load_dwordx4 v68, s[52:55], s67 offen nt lds
    s_mov_b32 m0, 33792
    s_add_u32 s67, s77, 1024
    buffer_load_dwordx4 v68, s[52:55], s67 offen nt lds
    s_mov_b32 m0, 34816
    s_add_u32 s67, s77, 2048
    buffer_load_dwordx4 v68, s[52:55], s67 offen nt lds
    s_mov_b32 m0, 35840
    s_add_u32 s67, s77, 3072
    buffer_load_dwordx4 v68, s[52:55], s67 offen nt lds
    s_mov_b32 m0, 36864
    s_add_u32 s67, s77, 4096
    buffer_load_dwordx4 v68, s[52:55], s67 offen nt lds
    s_mov_b32 m0, 37888
    s_add_u32 s67, s77, 5120
    buffer_load_dwordx4 v68, s[52:55], s67 offen nt lds
    s_mov_b32 m0, 38912
    s_add_u32 s67, s77, 6144
    buffer_load_dwordx4 v68, s[52:55], s67 offen nt lds
    s_mov_b32 m0, 39936
    s_add_u32 s67, s77, 7168
    buffer_load_dwordx4 v68, s[52:55], s67 offen nt lds
    s_branch .Lattn_s
.Lw3:
    s_load_dword s44, s[42:43], 0
    v_and_b32 v32, 1, v2
    v_and_b32 v33, 2, v2
    v_lshl_or_b32 v32, v33, 2, v32
    v_lshrrev_b32 v33, 1, v2
    v_and_b32 v33, 6, v33
    v_or_b32 v32, v32, v33
    v_xor_b32 v32, v32, v3
    v_lshlrev_b32 v32, 4, v32
    v_lshl_add_u32 v32, v2, 10, v32
    s_lshl_b32 s64, s62, 14

    v_xor_b32 v20, 0, v32
    v_xor_b32 v21, 64, v32
    v_xor_b32 v22, 128, v32
    v_xor_b32 v23, 192, v32
    v_add_u32 v16, s64, v20
    v_add_u32 v20, 131072, v20
    v_add_u32 v17, s64, v21
    v_add_u32 v21, 131072, v21
    v_add_u32 v18, s64, v22
    v_add_u32 v22, 131072, v22
    v_add_u32 v19, s64, v23
    v_add_u32 v23, 131072, v23
    v_lshrrev_b32 v32, 2, v1
    v_and_b32 v33, 1, v32
    v_and_b32 v34, 2, v32
    v_lshl_or_b32 v33, v34, 2, v33
    v_lshrrev_b32 v34, 1, v32
    v_and_b32 v34, 6, v34
    v_or_b32 v33, v33, v34
    v_and_b32 v34, 3, v1
    v_lshlrev_b32 v35, 1, v34
    s_and_b32 s65, s62, 1
    s_lshl_b32 s65, s65, 3
    v_or_b32 v35, s65, v35
    v_xor_b32 v35, v35, v33
    v_lshlrev_b32 v35, 4, v35
    v_lshl_add_u32 v35, v32, 10, v35
    s_lshr_b32 s65, s62, 1
    s_lshl_b32 s65, s65, 8
    v_add_u32 v35, s65, v35
    v_and_b32 v34, 1, v34
    v_lshl_or_b32 v35, v34, 3, v35

    v_xor_b32 v24, 0, v35
    v_add_u32 v28, 0x10000, v24
    v_xor_b32 v25, 8, v35
    v_add_u32 v29, 0x10000, v25
    v_xor_b32 v26, 16, v35
    v_add_u32 v30, 0x10000, v26
    v_xor_b32 v27, 24, v35
    v_add_u32 v31, 0x10000, v27
    s_waitcnt lgkmcnt(0)
    s_add_u32 s44, s44, 2654435769
    s_cmp_ge_u32 s63, 2
    s_cbranch_scc1 .wl_50
    v_mov_b32 v47, 152576
.wf_51:
    ds_read_b32 v46, v47
    s_waitcnt lgkmcnt(0)
    v_readfirstlane_b32 s63, v46
    s_nop 1
    s_cmp_ge_u32 s63, 2
    s_cbranch_scc1 .wfok_52
    s_add_u32 s47, s47, 1
    s_cmp_lt_u32 s47, 2000000
    s_cbranch_scc1 .wf_51
    s_branch .Lend
.wfok_52:
.wl_50:
    ds_read_b64_tr_b16 v[144:145], v24 offset:0
    ds_read_b64_tr_b16 v[146:147], v24 offset:16384
    ds_read_b64_tr_b16 v[148:149], v25 offset:0
    ds_read_b64_tr_b16 v[150:151], v25 offset:16384
    ds_read_b64_tr_b16 v[152:153], v26 offset:0
    ds_read_b64_tr_b16 v[154:155], v26 offset:16384
    ds_read_b64_tr_b16 v[156:157], v27 offset:0
    ds_read_b64_tr_b16 v[158:159], v27 offset:16384
    s_lshr_b32 s65, s62, 1
    s_cmp_lg_u32 s65, 0
    s_cbranch_scc1 .ps_53
    s_waitcnt lgkmcnt(0)
    ds_read_b128 v[80:83], v16 offset:0
    ds_read_b128 v[84:87], v17 offset:0
    ds_read_b128 v[88:91], v18 offset:0
    ds_read_b128 v[92:95], v19 offset:0
    ds_read_b128 v[96:99], v16 offset:256
    ds_read_b128 v[100:103], v17 offset:256
    ds_read_b128 v[104:107], v18 offset:256
    ds_read_b128 v[108:111], v19 offset:256
    ds_read_b128 v[112:115], v16 offset:512
    ds_read_b128 v[116:119], v17 offset:512
    ds_read_b128 v[120:123], v18 offset:512
    ds_read_b128 v[124:127], v19 offset:512
    s_waitcnt lgkmcnt(4)
    ds_read_b128 v[128:131], v16 offset:768
    ds_read_b128 v[132:135], v17 offset:768
    ds_read_b128 v[136:139], v18 offset:768
    ds_read_b128 v[140:143], v19 offset:768
.ps_53:
    s_waitcnt lgkmcnt(0)
    v_mov_b32 v47, 152636
    v_mov_b32 v46, 1
    s_mov_b64 exec, 1
    ds_add_u32 v47, v46
    s_mov_b64 exec, -1
    s_cmp_ge_u32 s63, 4
    s_cbranch_scc1 .wl_54
    v_mov_b32 v47, 152576
.wf_55:
    ds_read_b32 v46, v47
    s_waitcnt lgkmcnt(0)
    v_readfirstlane_b32 s63, v46
    s_nop 1
    s_cmp_ge_u32 s63, 4
    s_cbranch_scc1 .wfok_56
    s_add_u32 s47, s47, 1
    s_cmp_lt_u32 s47, 2000000
    s_cbranch_scc1 .wf_55
    s_branch .Lend
.wfok_56:
.wl_54:
    ds_read_b64_tr_b16 v[160:161], v24 offset:32768
    ds_read_b64_tr_b16 v[162:163], v24 offset:49152
    ds_read_b64_tr_b16 v[164:165], v25 offset:32768
    ds_read_b64_tr_b16 v[166:167], v25 offset:49152
    ds_read_b64_tr_b16 v[168:169], v26 offset:32768
    ds_read_b64_tr_b16 v[170:171], v26 offset:49152
    ds_read_b64_tr_b16 v[172:173], v27 offset:32768
    ds_read_b64_tr_b16 v[174:175], v27 offset:49152
    s_lshr_b32 s65, s62, 1
    s_cmp_lg_u32 s65, 1
    s_cbranch_scc1 .ps_57
    s_waitcnt lgkmcnt(0)
    ds_read_b128 v[80:83], v16 offset:0
    ds_read_b128 v[84:87], v17 offset:0
    ds_read_b128 v[88:91], v18 offset:0
    ds_read_b128 v[92:95], v19 offset:0
    ds_read_b128 v[96:99], v16 offset:256
    ds_read_b128 v[100:103], v17 offset:256
    ds_read_b128 v[104:107], v18 offset:256
    ds_read_b128 v[108:111], v19 offset:256
    ds_read_b128 v[112:115], v16 offset:512
    ds_read_b128 v[116:119], v17 offset:512
    ds_read_b128 v[120:123], v18 offset:512
    ds_read_b128 v[124:127], v19 offset:512
    s_waitcnt lgkmcnt(4)
    ds_read_b128 v[128:131], v16 offset:768
    ds_read_b128 v[132:135], v17 offset:768
    ds_read_b128 v[136:139], v18 offset:768
    ds_read_b128 v[140:143], v19 offset:768
.ps_57:
    s_waitcnt lgkmcnt(0)
    v_mov_b32 v47, 152640
    v_mov_b32 v46, 1
    s_mov_b64 exec, 1
    ds_add_u32 v47, v46
    s_mov_b64 exec, -1
    v_mov_b32 v47, 152624
.wf_58:
    ds_read_b32 v46, v47
    s_waitcnt lgkmcnt(0)
    v_readfirstlane_b32 s65, v46
    s_nop 1
    s_cmp_ge_u32 s65, 1
    s_cbranch_scc1 .wfok_59
    s_sleep 1
    s_add_u32 s47, s47, 1
    s_cmp_lt_u32 s47, 2000000
    s_cbranch_scc1 .wf_58
    s_branch .Lend
.wfok_59:
    s_lshl_b32 s64, s74, 5
    s_lshl_b32 s65, s76, 4
    s_add_u32 s64, s64, s65
    s_add_u32 s64, s64, 8
    s_lshl_b32 s64, s64, 11
    s_add_u32 s64, s64, 786432
    v_lshlrev_b32 v32, 4, v1

    s_add_u32 s66, s64, 0
    buffer_load_dwordx4 v[208:211], v32, s[48:51], s66 offen offset:0 sc1
    buffer_load_dwordx4 v[212:215], v32, s[48:51], s66 offen offset:1024 sc1
    buffer_load_dwordx4 v[216:219], v32, s[48:51], s66 offen offset:2048 sc1
    buffer_load_dwordx4 v[220:223], v32, s[48:51], s66 offen offset:3072 sc1
    s_add_u32 s66, s64, 4096
    buffer_load_dwordx4 v[224:227], v32, s[48:51], s66 offen offset:0 sc1
    buffer_load_dwordx4 v[228:231], v32, s[48:51], s66 offen offset:1024 sc1
    buffer_load_dwordx4 v[232:235], v32, s[48:51], s66 offen offset:2048 sc1
    buffer_load_dwordx4 v[236:239], v32, s[48:51], s66 offen offset:3072 sc1
    s_add_u32 s66, s64, 8192
    buffer_load_dwordx4 v[48:51], v32, s[48:51], s66 offen offset:0 sc1
    buffer_load_dwordx4 v[52:55], v32, s[48:51], s66 offen offset:1024 sc1
    buffer_load_dwordx4 v[56:59], v32, s[48:51], s66 offen offset:2048 sc1
    buffer_load_dwordx4 v[60:63], v32, s[48:51], s66 offen offset:3072 sc1
    s_add_u32 s66, s64, 12288
    buffer_load_dwordx4 v[64:67], v32, s[48:51], s66 offen offset:0 sc1
    buffer_load_dwordx4 v[68:71], v32, s[48:51], s66 offen offset:1024 sc1
    buffer_load_dwordx4 v[72:75], v32, s[48:51], s66 offen offset:2048 sc1
    buffer_load_dwordx4 v[76:79], v32, s[48:51], s66 offen offset:3072 sc1
    v_mov_b32 v47, 152632
    v_mov_b32 v46, 1
    s_mov_b64 exec, 1
    ds_add_u32 v47, v46
    s_mov_b64 exec, -1
    s_cmp_ge_u32 s63, 6
    s_cbranch_scc1 .wl_60
    v_mov_b32 v47, 152576
.wf_61:
    ds_read_b32 v46, v47
    s_waitcnt lgkmcnt(0)
    v_readfirstlane_b32 s63, v46
    s_nop 1
    s_cmp_ge_u32 s63, 6
    s_cbranch_scc1 .wfok_62
    s_add_u32 s47, s47, 1
    s_cmp_lt_u32 s47, 2000000
    s_cbranch_scc1 .wf_61
    s_branch .Lend
.wfok_62:
.wl_60:
    ds_read_b64_tr_b16 v[176:177], v28 offset:0
    ds_read_b64_tr_b16 v[178:179], v28 offset:16384
    ds_read_b64_tr_b16 v[180:181], v29 offset:0
    ds_read_b64_tr_b16 v[182:183], v29 offset:16384
    ds_read_b64_tr_b16 v[184:185], v30 offset:0
    ds_read_b64_tr_b16 v[186:187], v30 offset:16384
    ds_read_b64_tr_b16 v[188:189], v31 offset:0
    ds_read_b64_tr_b16 v[190:191], v31 offset:16384
    s_lshr_b32 s65, s62, 1
    s_cmp_lg_u32 s65, 2
    s_cbranch_scc1 .ps_63
    s_waitcnt lgkmcnt(0)
    ds_read_b128 v[80:83], v16 offset:0
    ds_read_b128 v[84:87], v17 offset:0
    ds_read_b128 v[88:91], v18 offset:0
    ds_read_b128 v[92:95], v19 offset:0
    ds_read_b128 v[96:99], v16 offset:256
    ds_read_b128 v[100:103], v17 offset:256
    ds_read_b128 v[104:107], v18 offset:256
    ds_read_b128 v[108:111], v19 offset:256
    ds_read_b128 v[112:115], v16 offset:512
    ds_read_b128 v[116:119], v17 offset:512
    ds_read_b128 v[120:123], v18 offset:512
    ds_read_b128 v[124:127], v19 offset:512
    s_waitcnt lgkmcnt(4)
    ds_read_b128 v[128:131], v16 offset:768
    ds_read_b128 v[132:135], v17 offset:768
    ds_read_b128 v[136:139], v18 offset:768
    ds_read_b128 v[140:143], v19 offset:768
.ps_63:
    s_waitcnt lgkmcnt(0)
    v_mov_b32 v47, 152644
    v_mov_b32 v46, 1
    s_mov_b64 exec, 1
    ds_add_u32 v47, v46
    s_mov_b64 exec, -1
    v_lshrrev_b32 v34, 5, v1
    v_lshlrev_b32 v34, 8, v34
    v_and_b32 v35, 1, v3
    v_lshl_add_u32 v34, v35, 7, v34
    v_lshrrev_b32 v35, 1, v2
    v_lshl_add_u32 v34, v35, 4, v34
    v_and_b32 v35, 1, v1
    v_lshl_add_u32 v34, v35, 3, v34
    s_waitcnt vmcnt(0)

    s_branch .h2chk_64
.h2_65:
    s_add_u32 s66, s64, 0
    buffer_load_dwordx4 v[208:211], v32, s[48:51], s66 offen offset:0 sc1
    buffer_load_dwordx4 v[212:215], v32, s[48:51], s66 offen offset:1024 sc1
    buffer_load_dwordx4 v[216:219], v32, s[48:51], s66 offen offset:2048 sc1
    buffer_load_dwordx4 v[220:223], v32, s[48:51], s66 offen offset:3072 sc1
    s_add_u32 s66, s64, 4096
    buffer_load_dwordx4 v[224:227], v32, s[48:51], s66 offen offset:0 sc1
    buffer_load_dwordx4 v[228:231], v32, s[48:51], s66 offen offset:1024 sc1
    buffer_load_dwordx4 v[232:235], v32, s[48:51], s66 offen offset:2048 sc1
    buffer_load_dwordx4 v[236:239], v32, s[48:51], s66 offen offset:3072 sc1
    s_add_u32 s66, s64, 8192
    buffer_load_dwordx4 v[48:51], v32, s[48:51], s66 offen offset:0 sc1
    buffer_load_dwordx4 v[52:55], v32, s[48:51], s66 offen offset:1024 sc1
    buffer_load_dwordx4 v[56:59], v32, s[48:51], s66 offen offset:2048 sc1
    buffer_load_dwordx4 v[60:63], v32, s[48:51], s66 offen offset:3072 sc1
    s_add_u32 s66, s64, 12288
    buffer_load_dwordx4 v[64:67], v32, s[48:51], s66 offen offset:0 sc1
    buffer_load_dwordx4 v[68:71], v32, s[48:51], s66 offen offset:1024 sc1
    buffer_load_dwordx4 v[72:75], v32, s[48:51], s66 offen offset:2048 sc1
    buffer_load_dwordx4 v[76:79], v32, s[48:51], s66 offen offset:3072 sc1
    s_waitcnt vmcnt(0)
.h2chk_64:
    v_xor_b32 v33, s44, v209
    v_bitop3_b32 v33, v33, v211, s44 bitop3:0xf6
    v_bitop3_b32 v33, v33, v213, s44 bitop3:0xf6
    v_bitop3_b32 v33, v33, v215, s44 bitop3:0xf6
    v_bitop3_b32 v33, v33, v217, s44 bitop3:0xf6
    v_bitop3_b32 v33, v33, v219, s44 bitop3:0xf6
    v_bitop3_b32 v33, v33, v221, s44 bitop3:0xf6
    v_bitop3_b32 v33, v33, v223, s44 bitop3:0xf6
    v_bitop3_b32 v33, v33, v225, s44 bitop3:0xf6
    v_bitop3_b32 v33, v33, v227, s44 bitop3:0xf6
    v_bitop3_b32 v33, v33, v229, s44 bitop3:0xf6
    v_bitop3_b32 v33, v33, v231, s44 bitop3:0xf6
    v_bitop3_b32 v33, v33, v233, s44 bitop3:0xf6
    v_bitop3_b32 v33, v33, v235, s44 bitop3:0xf6
    v_bitop3_b32 v33, v33, v237, s44 bitop3:0xf6
    v_bitop3_b32 v33, v33, v239, s44 bitop3:0xf6
    v_bitop3_b32 v33, v33, v49, s44 bitop3:0xf6
    v_bitop3_b32 v33, v33, v51, s44 bitop3:0xf6
    v_bitop3_b32 v33, v33, v53, s44 bitop3:0xf6
    v_bitop3_b32 v33, v33, v55, s44 bitop3:0xf6
    v_bitop3_b32 v33, v33, v57, s44 bitop3:0xf6
    v_bitop3_b32 v33, v33, v59, s44 bitop3:0xf6
    v_bitop3_b32 v33, v33, v61, s44 bitop3:0xf6
    v_bitop3_b32 v33, v33, v63, s44 bitop3:0xf6
    v_bitop3_b32 v33, v33, v65, s44 bitop3:0xf6
    v_bitop3_b32 v33, v33, v67, s44 bitop3:0xf6
    v_bitop3_b32 v33, v33, v69, s44 bitop3:0xf6
    v_bitop3_b32 v33, v33, v71, s44 bitop3:0xf6
    v_bitop3_b32 v33, v33, v73, s44 bitop3:0xf6
    v_bitop3_b32 v33, v33, v75, s44 bitop3:0xf6
    v_bitop3_b32 v33, v33, v77, s44 bitop3:0xf6
    v_bitop3_b32 v33, v33, v79, s44 bitop3:0xf6
    v_cmp_ne_u32 vcc, 0, v33
    s_nop 1
    s_cbranch_vccz .tok_66
    s_sleep 2
    s_add_u32 s47, s47, 1
    s_cmp_lt_u32 s47, 2000000
    s_cbranch_scc1 .h2_65
    s_branch .Lend
.tok_66:
    v_xor_b32 v36, 64, v34
    v_add_u32 v36, 139264, v36
    ds_write2_b32 v36, v208, v210 offset0:0 offset1:1
    ds_write2_b32 v36, v212, v214 offset0:128 offset1:129
    v_xor_b32 v37, 80, v34
    v_add_u32 v37, 140288, v37
    ds_write2_b32 v37, v216, v218 offset0:0 offset1:1
    ds_write2_b32 v37, v220, v222 offset0:128 offset1:129
    v_xor_b32 v36, 192, v34
    v_add_u32 v36, 141312, v36
    ds_write2_b32 v36, v224, v226 offset0:0 offset1:1
    ds_write2_b32 v36, v228, v230 offset0:128 offset1:129
    v_xor_b32 v37, 208, v34
    v_add_u32 v37, 142336, v37
    ds_write2_b32 v37, v232, v234 offset0:0 offset1:1
    ds_write2_b32 v37, v236, v238 offset0:128 offset1:129
    s_waitcnt lgkmcnt(4)
    v_xor_b32 v36, 96, v34
    v_add_u32 v36, 143360, v36
    ds_write2_b32 v36, v48, v50 offset0:0 offset1:1
    ds_write2_b32 v36, v52, v54 offset0:128 offset1:129
    v_xor_b32 v37, 112, v34
    v_add_u32 v37, 144384, v37
    ds_write2_b32 v37, v56, v58 offset0:0 offset1:1
    ds_write2_b32 v37, v60, v62 offset0:128 offset1:129
    v_xor_b32 v36, 224, v34
    v_add_u32 v36, 145408, v36
    ds_write2_b32 v36, v64, v66 offset0:0 offset1:1
    ds_write2_b32 v36, v68, v70 offset0:128 offset1:129
    v_xor_b32 v37, 240, v34
    v_add_u32 v37, 146432, v37
    ds_write2_b32 v37, v72, v74 offset0:0 offset1:1
    ds_write2_b32 v37, v76, v78 offset0:128 offset1:129
    s_waitcnt lgkmcnt(4)
    s_waitcnt lgkmcnt(0)
    v_mov_b32 v47, 152580
    v_mov_b32 v46, 1
    s_mov_b64 exec, 1
    ds_add_u32 v47, v46
    s_mov_b64 exec, -1
    s_branch .Lattn_s
.Lw47:
    s_load_dword s44, s[42:43], 0
    v_and_b32 v32, 1, v2
    v_and_b32 v33, 2, v2
    v_lshl_or_b32 v32, v33, 2, v32
    v_lshrrev_b32 v33, 1, v2
    v_and_b32 v33, 6, v33
    v_or_b32 v32, v32, v33
    v_xor_b32 v32, v32, v3
    v_lshlrev_b32 v32, 4, v32
    v_lshl_add_u32 v32, v2, 10, v32
    s_lshl_b32 s64, s62, 14

    v_xor_b32 v20, 0, v32
    v_xor_b32 v21, 64, v32
    v_xor_b32 v22, 128, v32
    v_xor_b32 v23, 192, v32
    v_add_u32 v16, s64, v20
    v_add_u32 v20, 131072, v20
    v_add_u32 v17, s64, v21
    v_add_u32 v21, 131072, v21
    v_add_u32 v18, s64, v22
    v_add_u32 v22, 131072, v22
    v_add_u32 v19, s64, v23
    v_add_u32 v23, 131072, v23
    v_lshrrev_b32 v32, 2, v1
    v_and_b32 v33, 1, v32
    v_and_b32 v34, 2, v32
    v_lshl_or_b32 v33, v34, 2, v33
    v_lshrrev_b32 v34, 1, v32
    v_and_b32 v34, 6, v34
    v_or_b32 v33, v33, v34
    v_and_b32 v34, 3, v1
    v_lshlrev_b32 v35, 1, v34
    s_and_b32 s65, s62, 1
    s_lshl_b32 s65, s65, 3
    v_or_b32 v35, s65, v35
    v_xor_b32 v35, v35, v33
    v_lshlrev_b32 v35, 4, v35
    v_lshl_add_u32 v35, v32, 10, v35
    s_lshr_b32 s65, s62, 1
    s_lshl_b32 s65, s65, 8
    v_add_u32 v35, s65, v35
    v_and_b32 v34, 1, v34
    v_lshl_or_b32 v35, v34, 3, v35

    v_xor_b32 v24, 0, v35
    v_add_u32 v28, 0x10000, v24
    v_xor_b32 v25, 8, v35
    v_add_u32 v29, 0x10000, v25
    v_xor_b32 v26, 16, v35
    v_add_u32 v30, 0x10000, v26
    v_xor_b32 v27, 24, v35
    v_add_u32 v31, 0x10000, v27
    s_sub_u32 s72, s3, 4
    s_waitcnt lgkmcnt(0)
    s_add_u32 s44, s44, 2654435769
    s_cmp_ge_u32 s63, 2
    s_cbranch_scc1 .wl_67
    v_mov_b32 v47, 152576
.wf_68:
    ds_read_b32 v46, v47
    s_waitcnt lgkmcnt(0)
    v_readfirstlane_b32 s63, v46
    s_nop 1
    s_cmp_ge_u32 s63, 2
    s_cbranch_scc1 .wfok_69
    s_add_u32 s47, s47, 1
    s_cmp_lt_u32 s47, 2000000
    s_cbranch_scc1 .wf_68
    s_branch .Lend
.wfok_69:
.wl_67:
    ds_read_b64_tr_b16 v[144:145], v24 offset:0
    ds_read_b64_tr_b16 v[146:147], v24 offset:16384
    ds_read_b64_tr_b16 v[148:149], v25 offset:0
    ds_read_b64_tr_b16 v[150:151], v25 offset:16384
    ds_read_b64_tr_b16 v[152:153], v26 offset:0
    ds_read_b64_tr_b16 v[154:155], v26 offset:16384
    ds_read_b64_tr_b16 v[156:157], v27 offset:0
    ds_read_b64_tr_b16 v[158:159], v27 offset:16384
    s_lshr_b32 s65, s62, 1
    s_cmp_lg_u32 s65, 0
    s_cbranch_scc1 .ps_70
    s_waitcnt lgkmcnt(0)
    ds_read_b128 v[80:83], v16 offset:0
    ds_read_b128 v[84:87], v17 offset:0
    ds_read_b128 v[88:91], v18 offset:0
    ds_read_b128 v[92:95], v19 offset:0
    ds_read_b128 v[96:99], v16 offset:256
    ds_read_b128 v[100:103], v17 offset:256
    ds_read_b128 v[104:107], v18 offset:256
    ds_read_b128 v[108:111], v19 offset:256
    ds_read_b128 v[112:115], v16 offset:512
    ds_read_b128 v[116:119], v17 offset:512
    ds_read_b128 v[120:123], v18 offset:512
    ds_read_b128 v[124:127], v19 offset:512
    s_waitcnt lgkmcnt(4)
    ds_read_b128 v[128:131], v16 offset:768
    ds_read_b128 v[132:135], v17 offset:768
    ds_read_b128 v[136:139], v18 offset:768
    ds_read_b128 v[140:143], v19 offset:768
.ps_70:
    s_waitcnt lgkmcnt(0)
    v_mov_b32 v47, 152636
    v_mov_b32 v46, 1
    s_mov_b64 exec, 1
    ds_add_u32 v47, v46
    s_mov_b64 exec, -1
    s_cmp_ge_u32 s63, 4
    s_cbranch_scc1 .wl_71
    v_mov_b32 v47, 152576
.wf_72:
    ds_read_b32 v46, v47
    s_waitcnt lgkmcnt(0)
    v_readfirstlane_b32 s63, v46
    s_nop 1
    s_cmp_ge_u32 s63, 4
    s_cbranch_scc1 .wfok_73
    s_add_u32 s47, s47, 1
    s_cmp_lt_u32 s47, 2000000
    s_cbranch_scc1 .wf_72
    s_branch .Lend
.wfok_73:
.wl_71:
    ds_read_b64_tr_b16 v[160:161], v24 offset:32768
    ds_read_b64_tr_b16 v[162:163], v24 offset:49152
    ds_read_b64_tr_b16 v[164:165], v25 offset:32768
    ds_read_b64_tr_b16 v[166:167], v25 offset:49152
    ds_read_b64_tr_b16 v[168:169], v26 offset:32768
    ds_read_b64_tr_b16 v[170:171], v26 offset:49152
    ds_read_b64_tr_b16 v[172:173], v27 offset:32768
    ds_read_b64_tr_b16 v[174:175], v27 offset:49152
    s_lshr_b32 s65, s62, 1
    s_cmp_lg_u32 s65, 1
    s_cbranch_scc1 .ps_74
    s_waitcnt lgkmcnt(0)
    ds_read_b128 v[80:83], v16 offset:0
    ds_read_b128 v[84:87], v17 offset:0
    ds_read_b128 v[88:91], v18 offset:0
    ds_read_b128 v[92:95], v19 offset:0
    ds_read_b128 v[96:99], v16 offset:256
    ds_read_b128 v[100:103], v17 offset:256
    ds_read_b128 v[104:107], v18 offset:256
    ds_read_b128 v[108:111], v19 offset:256
    ds_read_b128 v[112:115], v16 offset:512
    ds_read_b128 v[116:119], v17 offset:512
    ds_read_b128 v[120:123], v18 offset:512
    ds_read_b128 v[124:127], v19 offset:512
    s_waitcnt lgkmcnt(4)
    ds_read_b128 v[128:131], v16 offset:768
    ds_read_b128 v[132:135], v17 offset:768
    ds_read_b128 v[136:139], v18 offset:768
    ds_read_b128 v[140:143], v19 offset:768
.ps_74:
    s_waitcnt lgkmcnt(0)
    v_mov_b32 v47, 152640
    v_mov_b32 v46, 1
    s_mov_b64 exec, 1
    ds_add_u32 v47, v46
    s_mov_b64 exec, -1
    s_and_b32 s73, s2, 7
    s_lshl_b32 s73, s73, 2
    s_add_u32 s73, s73, s72
    s_lshr_b32 s69, s2, 7
    s_lshl_b32 s64, s73, 13
    s_lshl_b32 s65, s69, 9
    s_add_u32 s64, s64, s65
    s_add_u32 s64, s64, 524288
    s_add_u32 s66, s64, 4096
    v_lshlrev_b32 v32, 10, v3
    v_lshl_add_u32 v32, v2, 4, v32

    s_lshl_b32 s67, s73, 2
    s_bfe_u32 s65, s2, 0x20005
    s_add_u32 s67, s67, s65
    s_lshl_b32 s67, s67, 7
    s_add_u32 s67, s67, 90112
    s_add_u32 s60, s42, s67
    s_addc_u32 s61, s43, 0
    s_mov_b32 s65, 0
.sg_75:
    s_load_dwordx8 s[80:87], s[60:61], 0 glc
    s_waitcnt lgkmcnt(0)
    s_cmp_lg_u32 s80, s44
    s_cbranch_scc1 .sgrt_77
    s_cmp_lg_u32 s81, s44
    s_cbranch_scc1 .sgrt_77
    s_cmp_lg_u32 s82, s44
    s_cbranch_scc1 .sgrt_77
    s_cmp_lg_u32 s83, s44
    s_cbranch_scc1 .sgrt_77
    s_cmp_lg_u32 s84, s44
    s_cbranch_scc1 .sgrt_77
    s_cmp_lg_u32 s85, s44
    s_cbranch_scc1 .sgrt_77
    s_cmp_lg_u32 s86, s44
    s_cbranch_scc1 .sgrt_77
    s_cmp_lg_u32 s87, s44
    s_cbranch_scc1 .sgrt_77
    s_branch .sgok_76
.sgrt_77:
    s_sleep 10
    s_add_u32 s65, s65, 1
    s_cmp_lt_u32 s65, 4000
    s_cbranch_scc1 .sg_75
.sgok_76:
    buffer_load_dwordx4 v[208:211], v32, s[48:51], s64 offen offset:0 sc1
    buffer_load_dwordx4 v[212:215], v32, s[48:51], s64 offen offset:256 sc1
    buffer_load_dwordx4 v[216:219], v32, s[48:51], s66 offen offset:0 sc1
    buffer_load_dwordx4 v[220:223], v32, s[48:51], s66 offen offset:256 sc1
    s_waitcnt vmcnt(0)
    s_branch .h1bchk_78
.h1b_79:
    buffer_load_dwordx4 v[208:211], v32, s[48:51], s64 offen offset:0 sc1
    buffer_load_dwordx4 v[212:215], v32, s[48:51], s64 offen offset:256 sc1
    buffer_load_dwordx4 v[216:219], v32, s[48:51], s66 offen offset:0 sc1
    buffer_load_dwordx4 v[220:223], v32, s[48:51], s66 offen offset:256 sc1
    s_waitcnt vmcnt(0)
.h1bchk_78:
    v_xor_b32 v33, s44, v209
    v_bitop3_b32 v33, v33, v211, s44 bitop3:0xf6
    v_bitop3_b32 v33, v33, v213, s44 bitop3:0xf6
    v_bitop3_b32 v33, v33, v215, s44 bitop3:0xf6
    v_bitop3_b32 v33, v33, v217, s44 bitop3:0xf6
    v_bitop3_b32 v33, v33, v219, s44 bitop3:0xf6
    v_bitop3_b32 v33, v33, v221, s44 bitop3:0xf6
    v_bitop3_b32 v33, v33, v223, s44 bitop3:0xf6
    v_cmp_ne_u32 vcc, 0, v33
    s_nop 1
    s_cbranch_vccz .tok_80
    s_sleep 2
    s_add_u32 s47, s47, 1
    s_cmp_lt_u32 s47, 2000000
    s_cbranch_scc1 .h1b_79
    s_branch .Lend
.tok_80:
    v_mov_b32 v209, v210
    v_mov_b32 v213, v214
    v_mov_b32 v217, v218
    v_mov_b32 v221, v222
    v_and_b32 v48, 0x3f803f80, v12
    v_and_b32 v49, 0x3f803f80, v13
    v_and_b32 v50, 0x3f803f80, v14
    v_and_b32 v51, 0x3f803f80, v15
    s_nop 1
    v_mfma_f32_16x16x16_bf16 v[240:243], v[48:49], v[208:209], 0
    v_mfma_f32_16x16x16_bf16 v[240:243], v[50:51], v[212:213], v[240:243]
    v_mfma_f32_16x16x16_bf16 v[240:243], v[48:49], v[216:217], v[240:243]
    v_mfma_f32_16x16x16_bf16 v[240:243], v[50:51], v[220:221], v[240:243]
    s_nop 7
    s_nop 1
    v_mul_f32 v240, 1040356334, v240
    v_mul_f32 v241, 1040356334, v241
    v_mul_f32 v242, 1040356334, v242
    v_mul_f32 v243, 1040356334, v243
    v_cvt_pk_bf16_f32 v36, v240, v241
    v_cvt_pk_bf16_f32 v37, v242, v243
    v_lshlrev_b32 v33, 3, v1
    s_lshl_b32 s65, s72, 8
    s_add_u32 s65, s65, 153600
    v_add_u32 v33, s65, v33
    v_cmp_gt_u32 vcc, 32, v1
    s_and_saveexec_b64 s[70:71], vcc
    ds_write_b64 v33, v[36:37]
    s_mov_b64 exec, s[70:71]
    s_waitcnt lgkmcnt(0)

    v_mov_b32 v47, 152588
    v_mov_b32 v46, 1
    s_mov_b64 exec, 1
    ds_add_u32 v47, v46
    s_mov_b64 exec, -1
    s_cmp_ge_u32 s63, 6
    s_cbranch_scc1 .wl_81
    v_mov_b32 v47, 152576
.wf_82:
    ds_read_b32 v46, v47
    s_waitcnt lgkmcnt(0)
    v_readfirstlane_b32 s63, v46
    s_nop 1
    s_cmp_ge_u32 s63, 6
    s_cbranch_scc1 .wfok_83
    s_add_u32 s47, s47, 1
    s_cmp_lt_u32 s47, 2000000
    s_cbranch_scc1 .wf_82
    s_branch .Lend
.wfok_83:
.wl_81:
    ds_read_b64_tr_b16 v[176:177], v28 offset:0
    ds_read_b64_tr_b16 v[178:179], v28 offset:16384
    ds_read_b64_tr_b16 v[180:181], v29 offset:0
    ds_read_b64_tr_b16 v[182:183], v29 offset:16384
    ds_read_b64_tr_b16 v[184:185], v30 offset:0
    ds_read_b64_tr_b16 v[186:187], v30 offset:16384
    ds_read_b64_tr_b16 v[188:189], v31 offset:0
    ds_read_b64_tr_b16 v[190:191], v31 offset:16384
    s_lshr_b32 s65, s62, 1
    s_cmp_lg_u32 s65, 2
    s_cbranch_scc1 .ps_84
    s_waitcnt lgkmcnt(0)
    ds_read_b128 v[80:83], v16 offset:0
    ds_read_b128 v[84:87], v17 offset:0
    ds_read_b128 v[88:91], v18 offset:0
    ds_read_b128 v[92:95], v19 offset:0
    ds_read_b128 v[96:99], v16 offset:256
    ds_read_b128 v[100:103], v17 offset:256
    ds_read_b128 v[104:107], v18 offset:256
    ds_read_b128 v[108:111], v19 offset:256
    ds_read_b128 v[112:115], v16 offset:512
    ds_read_b128 v[116:119], v17 offset:512
    ds_read_b128 v[120:123], v18 offset:512
    ds_read_b128 v[124:127], v19 offset:512
    s_waitcnt lgkmcnt(4)
    ds_read_b128 v[128:131], v16 offset:768
    ds_read_b128 v[132:135], v17 offset:768
    ds_read_b128 v[136:139], v18 offset:768
    ds_read_b128 v[140:143], v19 offset:768
.ps_84:
    s_waitcnt lgkmcnt(0)
    v_mov_b32 v47, 152644
    v_mov_b32 v46, 1
    s_mov_b64 exec, 1
    ds_add_u32 v47, v46
    s_mov_b64 exec, -1
    s_cmp_lt_u32 s62, 6
    s_cbranch_scc1 .ol_85
    s_add_u32 s64, s62, 1
    s_cmp_ge_u32 s63, s64
    s_cbranch_scc1 .ol2_86
    v_mov_b32 v47, 152576
.wf_87:
    ds_read_b32 v46, v47
    s_waitcnt lgkmcnt(0)
    v_readfirstlane_b32 s63, v46
    s_nop 1
    s_cmp_ge_u32 s63, s64
    s_cbranch_scc1 .wfok_88
    s_add_u32 s47, s47, 1
    s_cmp_lt_u32 s47, 2000000
    s_cbranch_scc1 .wf_87
    s_branch .Lend
.wfok_88:
.ol2_86:
    ds_read_b128 v[80:83], v16 offset:0
    ds_read_b128 v[84:87], v17 offset:0
    ds_read_b128 v[88:91], v18 offset:0
    ds_read_b128 v[92:95], v19 offset:0
    ds_read_b128 v[96:99], v16 offset:256
    ds_read_b128 v[100:103], v17 offset:256
    ds_read_b128 v[104:107], v18 offset:256
    ds_read_b128 v[108:111], v19 offset:256
    ds_read_b128 v[112:115], v16 offset:512
    ds_read_b128 v[116:119], v17 offset:512
    ds_read_b128 v[120:123], v18 offset:512
    ds_read_b128 v[124:127], v19 offset:512
    s_waitcnt lgkmcnt(4)
    ds_read_b128 v[128:131], v16 offset:768
    ds_read_b128 v[132:135], v17 offset:768
    ds_read_b128 v[136:139], v18 offset:768
    ds_read_b128 v[140:143], v19 offset:768
.ol_85:
    s_branch .Lattn_s
.Lattn:
    s_cmp_ge_u32 s63, 2
    s_cbranch_scc1 .wl_89
    v_mov_b32 v47, 152576
.wf_90:
    ds_read_b32 v46, v47
    s_waitcnt lgkmcnt(0)
    v_readfirstlane_b32 s63, v46
    s_nop 1
    s_cmp_ge_u32 s63, 2
    s_cbranch_scc1 .wfok_91
    s_add_u32 s47, s47, 1
    s_cmp_lt_u32 s47, 2000000
    s_cbranch_scc1 .wf_90
    s_branch .Lend
.wfok_91:
.wl_89:
    ds_read_b64_tr_b16 v[144:145], v24 offset:0
    ds_read_b64_tr_b16 v[146:147], v24 offset:16384
    ds_read_b64_tr_b16 v[148:149], v25 offset:0
    ds_read_b64_tr_b16 v[150:151], v25 offset:16384
    ds_read_b64_tr_b16 v[152:153], v26 offset:0
    ds_read_b64_tr_b16 v[154:155], v26 offset:16384
    ds_read_b64_tr_b16 v[156:157], v27 offset:0
    ds_read_b64_tr_b16 v[158:159], v27 offset:16384
    s_cmp_ge_u32 s63, 4
    s_cbranch_scc1 .wl_92
    v_mov_b32 v47, 152576
.wf_93:
    ds_read_b32 v46, v47
    s_waitcnt lgkmcnt(0)
    v_readfirstlane_b32 s63, v46
    s_nop 1
    s_cmp_ge_u32 s63, 4
    s_cbranch_scc1 .wfok_94
    s_add_u32 s47, s47, 1
    s_cmp_lt_u32 s47, 2000000
    s_cbranch_scc1 .wf_93
    s_branch .Lend
.wfok_94:
.wl_92:
    ds_read_b64_tr_b16 v[160:161], v24 offset:32768
    ds_read_b64_tr_b16 v[162:163], v24 offset:49152
    ds_read_b64_tr_b16 v[164:165], v25 offset:32768
    ds_read_b64_tr_b16 v[166:167], v25 offset:49152
    ds_read_b64_tr_b16 v[168:169], v26 offset:32768
    ds_read_b64_tr_b16 v[170:171], v26 offset:49152
    ds_read_b64_tr_b16 v[172:173], v27 offset:32768
    ds_read_b64_tr_b16 v[174:175], v27 offset:49152
.Lattn_own:
    s_add_u32 s64, s62, 1
    s_cmp_ge_u32 s63, s64
    s_cbranch_scc1 .own_95
    v_mov_b32 v47, 152576
.wf_96:
    ds_read_b32 v46, v47
    s_waitcnt lgkmcnt(0)
    v_readfirstlane_b32 s63, v46
    s_nop 1
    s_cmp_ge_u32 s63, s64
    s_cbranch_scc1 .wfok_97
    s_add_u32 s47, s47, 1
    s_cmp_lt_u32 s47, 2000000
    s_cbranch_scc1 .wf_96
    s_branch .Lend
.wfok_97:
.own_95:
    s_waitcnt lgkmcnt(0)
    ds_read_b128 v[80:83], v16 offset:0
    ds_read_b128 v[84:87], v17 offset:0
    ds_read_b128 v[88:91], v18 offset:0
    ds_read_b128 v[92:95], v19 offset:0
    ds_read_b128 v[96:99], v16 offset:256
    ds_read_b128 v[100:103], v17 offset:256
    ds_read_b128 v[104:107], v18 offset:256
    ds_read_b128 v[108:111], v19 offset:256
    ds_read_b128 v[112:115], v16 offset:512
    ds_read_b128 v[116:119], v17 offset:512
    ds_read_b128 v[120:123], v18 offset:512
    ds_read_b128 v[124:127], v19 offset:512
    s_waitcnt lgkmcnt(4)
    ds_read_b128 v[128:131], v16 offset:768
    ds_read_b128 v[132:135], v17 offset:768
    ds_read_b128 v[136:139], v18 offset:768
    ds_read_b128 v[140:143], v19 offset:768
.Lattn_s:
    v_mov_b32 v47, 152580
.wf_98:
    ds_read_b32 v46, v47
    s_waitcnt lgkmcnt(0)
    v_readfirstlane_b32 s65, v46
    s_nop 1
    s_cmp_ge_u32 s65, 2
    s_cbranch_scc1 .wfok_99
    s_add_u32 s47, s47, 1
    s_cmp_lt_u32 s47, 2000000
    s_cbranch_scc1 .wf_98
    s_branch .Lend
.wfok_99:
    ds_read_b128 v[208:211], v20 offset:0
    ds_read_b128 v[212:215], v21 offset:0
    ds_read_b128 v[216:219], v22 offset:0
    ds_read_b128 v[220:223], v23 offset:0
    ds_read_b128 v[224:227], v20 offset:256
    ds_read_b128 v[228:231], v21 offset:256
    ds_read_b128 v[232:235], v22 offset:256
    ds_read_b128 v[236:239], v23 offset:256
    s_waitcnt lgkmcnt(7)
    v_mfma_f32_16x16x32_bf16 v[240:243], v[80:83], v[208:211], 0
    ds_read_b128 v[208:211], v20 offset:512
    s_waitcnt lgkmcnt(7)
    v_mfma_f32_16x16x32_bf16 v[240:243], v[84:87], v[212:215], v[240:243]
    ds_read_b128 v[212:215], v21 offset:512
    s_waitcnt lgkmcnt(7)
    v_mfma_f32_16x16x32_bf16 v[240:243], v[88:91], v[216:219], v[240:243]
    ds_read_b128 v[216:219], v22 offset:512
    s_waitcnt lgkmcnt(7)
    v_mfma_f32_16x16x32_bf16 v[240:243], v[92:95], v[220:223], v[240:243]
    ds_read_b128 v[220:223], v23 offset:512
    s_waitcnt lgkmcnt(7)
    v_mfma_f32_16x16x32_bf16 v[240:243], v[96:99], v[224:227], v[240:243]
    ds_read_b128 v[224:227], v20 offset:768
    s_waitcnt lgkmcnt(7)
    v_mfma_f32_16x16x32_bf16 v[240:243], v[100:103], v[228:231], v[240:243]
    ds_read_b128 v[228:231], v21 offset:768
    s_waitcnt lgkmcnt(7)
    v_mfma_f32_16x16x32_bf16 v[240:243], v[104:107], v[232:235], v[240:243]
    ds_read_b128 v[232:235], v22 offset:768
    s_waitcnt lgkmcnt(7)
    v_mfma_f32_16x16x32_bf16 v[240:243], v[108:111], v[236:239], v[240:243]
    ds_read_b128 v[236:239], v23 offset:768
    s_waitcnt lgkmcnt(7)
    v_mfma_f32_16x16x32_bf16 v[240:243], v[112:115], v[208:211], v[240:243]
    s_waitcnt lgkmcnt(6)
    v_mfma_f32_16x16x32_bf16 v[240:243], v[116:119], v[212:215], v[240:243]
    s_waitcnt lgkmcnt(5)
    v_mfma_f32_16x16x32_bf16 v[240:243], v[120:123], v[216:219], v[240:243]
    s_waitcnt lgkmcnt(4)
    v_mfma_f32_16x16x32_bf16 v[240:243], v[124:127], v[220:223], v[240:243]
    s_waitcnt lgkmcnt(3)
    v_mfma_f32_16x16x32_bf16 v[240:243], v[128:131], v[224:227], v[240:243]
    s_waitcnt lgkmcnt(2)
    v_mfma_f32_16x16x32_bf16 v[240:243], v[132:135], v[228:231], v[240:243]
    s_waitcnt lgkmcnt(1)
    v_mfma_f32_16x16x32_bf16 v[240:243], v[136:139], v[232:235], v[240:243]
    s_waitcnt lgkmcnt(0)
    v_mfma_f32_16x16x32_bf16 v[240:243], v[140:143], v[236:239], v[240:243]
    v_lshlrev_b32 v32, 5, v2
    s_lshl_b32 s65, s62, 2
    v_add_u32 v32, s65, v32
    v_add_u32 v33, 151552, v32
    v_lshlrev_b32 v34, 5, v2
    v_add_u32 v34, 151552, v34
    s_nop 4
    v_max_f32 v244, v240, v241
    v_max3_f32 v244, v244, v242, v243
    v_mov_b32 v245, v244
    s_nop 1
    v_permlane16_swap_b32 v244, v245
    s_nop 1
    v_max_f32 v244, v244, v245
    v_mov_b32 v245, v244
    s_nop 1
    v_permlane32_swap_b32 v244, v245
    s_nop 1
    v_max_f32 v244, v244, v245
    v_cmp_gt_u32 vcc, 16, v1
    s_and_saveexec_b64 s[70:71], vcc
    ds_write_b32 v33, v244
    s_mov_b64 exec, s[70:71]
    s_waitcnt lgkmcnt(0)
    s_barrier
    ds_read_b128 v[208:211], v34
    ds_read_b128 v[212:215], v34 offset:16

    ds_read_b64_tr_b16 v[192:193], v28 offset:32768
    ds_read_b64_tr_b16 v[194:195], v28 offset:49152
    ds_read_b64_tr_b16 v[196:197], v29 offset:32768
    ds_read_b64_tr_b16 v[198:199], v29 offset:49152
    ds_read_b64_tr_b16 v[200:201], v30 offset:32768
    ds_read_b64_tr_b16 v[202:203], v30 offset:49152
    ds_read_b64_tr_b16 v[204:205], v31 offset:32768
    ds_read_b64_tr_b16 v[206:207], v31 offset:49152
    s_waitcnt lgkmcnt(8)
    v_max3_f32 v244, v208, v209, v210
    v_max3_f32 v244, v244, v211, v212
    v_max3_f32 v244, v244, v213, v214
    v_max_f32 v244, v244, v215

    v_sub_f32 v240, v240, v244
    v_sub_f32 v241, v241, v244
    v_sub_f32 v242, v242, v244
    v_sub_f32 v243, v243, v244
    v_exp_f32 v240, v240
    v_exp_f32 v241, v241
    v_exp_f32 v242, v242
    v_exp_f32 v243, v243
    s_nop 0
    v_add_f32 v245, v240, v241
    v_add_f32 v246, v242, v243
    v_cvt_pk_bf16_f32 v248, v240, v241
    v_cvt_pk_bf16_f32 v249, v242, v243
    v_add_f32 v245, v245, v246
    s_lshr_b32 s65, s62, 1
    s_lshl_b32 s65, s65, 10
    s_and_b32 s66, s62, 1
    s_lshl_b32 s66, s66, 3
    s_add_u32 s65, s65, s66
    s_add_u32 s65, s65, 147456
    v_lshlrev_b32 v34, 4, v1
    v_add_u32 v35, s65, v34
    ds_write_b64 v35, v[248:249]

    v_mov_b32 v246, v245
    s_nop 1
    v_permlane16_swap_b32 v245, v246
    s_nop 1
    v_add_f32 v245, v245, v246
    v_mov_b32 v246, v245
    s_nop 1
    v_permlane32_swap_b32 v245, v246
    s_nop 1
    v_add_f32 v245, v245, v246
    v_add_u32 v33, 152064, v32
    v_cmp_gt_u32 vcc, 16, v1
    s_and_saveexec_b64 s[70:71], vcc
    ds_write_b32 v33, v245
    s_mov_b64 exec, s[70:71]
    v_add_u32 v34, 147456, v34
    s_waitcnt lgkmcnt(0)
    s_barrier

    ds_read_b128 v[208:211], v34 offset:0
    ds_read_b128 v[212:215], v34 offset:1024
    ds_read_b128 v[216:219], v34 offset:2048
    ds_read_b128 v[220:223], v34 offset:3072
    s_waitcnt lgkmcnt(3)
    v_mfma_f32_16x16x32_bf16 v[112:115], v[144:147], v[208:211], 0
    v_mfma_f32_16x16x32_bf16 v[116:119], v[148:151], v[208:211], 0
    v_mfma_f32_16x16x32_bf16 v[120:123], v[152:155], v[208:211], 0
    v_mfma_f32_16x16x32_bf16 v[124:127], v[156:159], v[208:211], 0
    s_waitcnt lgkmcnt(2)
    v_mfma_f32_16x16x32_bf16 v[112:115], v[160:163], v[212:215], v[112:115]
    v_mfma_f32_16x16x32_bf16 v[116:119], v[164:167], v[212:215], v[116:119]
    v_mfma_f32_16x16x32_bf16 v[120:123], v[168:171], v[212:215], v[120:123]
    v_mfma_f32_16x16x32_bf16 v[124:127], v[172:175], v[212:215], v[124:127]
    s_waitcnt lgkmcnt(1)
    v_mfma_f32_16x16x32_bf16 v[112:115], v[176:179], v[216:219], v[112:115]
    v_mfma_f32_16x16x32_bf16 v[116:119], v[180:183], v[216:219], v[116:119]
    v_mfma_f32_16x16x32_bf16 v[120:123], v[184:187], v[216:219], v[120:123]
    v_mfma_f32_16x16x32_bf16 v[124:127], v[188:191], v[216:219], v[124:127]
    s_waitcnt lgkmcnt(0)
    v_mfma_f32_16x16x32_bf16 v[112:115], v[192:195], v[220:223], v[112:115]
    v_mfma_f32_16x16x32_bf16 v[116:119], v[196:199], v[220:223], v[116:119]
    v_mfma_f32_16x16x32_bf16 v[120:123], v[200:203], v[220:223], v[120:123]
    v_mfma_f32_16x16x32_bf16 v[124:127], v[204:207], v[220:223], v[124:127]
    v_lshlrev_b32 v34, 17, v2
    v_lshl_add_u32 v34, v3, 4, v34
    s_lshl_b32 s64, s76, 21
    s_lshl_b32 s65, s62, 14
    s_add_u32 s64, s64, s65
    s_lshl_b32 s65, s74, 13
    s_add_u32 s64, s64, s65
    s_lshl_b32 s65, s75, 7
    s_add_u32 s64, s64, s65
    s_add_u32 s64, s64, 4194304
    s_mov_b32 s67, 0xfffefffe

    v_lshlrev_b32 v36, 3, v3
    v_mov_b32 v37, s44
    v_lshrrev_b32 v36, v36, v37
    v_bfe_u32 v250, v36, 0, 1
    v_bfe_u32 v37, v36, 1, 1
    v_lshl_or_b32 v250, v37, 16, v250
    v_bfe_u32 v251, v36, 2, 1
    v_bfe_u32 v37, v36, 3, 1
    v_lshl_or_b32 v251, v37, 16, v251
    v_bfe_u32 v252, v36, 4, 1
    v_bfe_u32 v37, v36, 5, 1
    v_lshl_or_b32 v252, v37, 16, v252
    v_bfe_u32 v253, v36, 6, 1
    v_bfe_u32 v37, v36, 7, 1
    v_lshl_or_b32 v253, v37, 16, v253
    v_cvt_pk_bf16_f32 v128, v112, v113
    v_cvt_pk_bf16_f32 v129, v114, v115
    v_cvt_pk_bf16_f32 v130, v116, v117
    v_cvt_pk_bf16_f32 v131, v118, v119
    v_cvt_pk_bf16_f32 v132, v120, v121
    v_cvt_pk_bf16_f32 v133, v122, v123
    v_cvt_pk_bf16_f32 v134, v124, v125
    v_cvt_pk_bf16_f32 v135, v126, v127
    v_and_or_b32 v128, v128, s67, v250
    v_and_or_b32 v129, v129, s67, v251
    v_and_or_b32 v130, v130, s67, v252
    v_and_or_b32 v131, v131, s67, v253
    v_and_or_b32 v132, v132, s67, v250
    v_and_or_b32 v133, v133, s67, v251
    v_and_or_b32 v134, v134, s67, v252
    v_and_or_b32 v135, v135, s67, v253
    v_mov_b32 v136, v132
    v_mov_b32 v137, v133
    v_mov_b32 v138, v134
    v_mov_b32 v139, v135
    s_nop 0
    v_mov_b32_dpp v132, v128 row_ror:8 row_mask:0xf bank_mask:0x3
    v_mov_b32_dpp v133, v129 row_ror:8 row_mask:0xf bank_mask:0x3
    v_mov_b32_dpp v134, v130 row_ror:8 row_mask:0xf bank_mask:0x3
    v_mov_b32_dpp v135, v131 row_ror:8 row_mask:0xf bank_mask:0x3
    v_mov_b32_dpp v128, v136 row_ror:8 row_mask:0xf bank_mask:0xc
    v_mov_b32_dpp v129, v137 row_ror:8 row_mask:0xf bank_mask:0xc
    v_mov_b32_dpp v130, v138 row_ror:8 row_mask:0xf bank_mask:0xc
    v_mov_b32_dpp v131, v139 row_ror:8 row_mask:0xf bank_mask:0xc
    v_and_b32 v34, 7, v2
    v_lshlrev_b32 v34, 17, v34
    v_lshrrev_b32 v35, 3, v2
    v_lshl_add_u32 v34, v35, 6, v34
    v_lshl_add_u32 v34, v3, 4, v34
    s_add_u32 s65, s64, 0x100000
    buffer_store_dwordx4 v[128:131], v34, s[48:51], s64 offen sc1
    buffer_store_dwordx4 v[132:135], v34, s[48:51], s65 offen sc1

    s_cmp_eq_u32 s3, 0
    s_cbranch_scc1 .Lt0
    s_cmp_eq_u32 s3, 1
    s_cbranch_scc1 .Lt1
    s_cmp_eq_u32 s3, 2
    s_cbranch_scc1 .Lt2
    s_cmp_eq_u32 s3, 3
    s_cbranch_scc1 .Lt3
    s_branch .Lt47

.Lt0:
    v_lshrrev_b32 v32, 3, v2
    v_lshlrev_b32 v32, 10, v32
    v_lshl_add_u32 v32, v3, 8, v32
    v_and_b32 v33, 7, v2
    v_lshl_add_u32 v32, v33, 5, v32
    s_lshl_b32 s64, s45, 11
    s_add_u32 s64, s64, 1867776
    v_lshrrev_b32 v34, 3, v2
    v_lshlrev_b32 v34, 13, v34
    v_lshl_add_u32 v34, v3, 11, v34
    v_lshl_add_u32 v34, v33, 4, v34
    s_lshl_b32 s66, s45, 3
    s_add_u32 s66, s66, s46
    s_lshl_b32 s66, s66, 14
    s_add_u32 s66, s66, 4194304

    v_and_b32 v68, 3, v2
    v_lshlrev_b32 v69, 3, v68
    v_mov_b32 v70, s44
    v_lshrrev_b32 v69, v69, v70
    v_bfe_u32 v64, v69, 0, 1
    v_bfe_u32 v70, v69, 1, 1
    v_lshl_or_b32 v64, v70, 16, v64
    v_bfe_u32 v65, v69, 2, 1
    v_bfe_u32 v70, v69, 3, 1
    v_lshl_or_b32 v65, v70, 16, v65
    v_bfe_u32 v66, v69, 4, 1
    v_bfe_u32 v70, v69, 5, 1
    v_lshl_or_b32 v66, v70, 16, v66
    v_bfe_u32 v67, v69, 6, 1
    v_bfe_u32 v70, v69, 7, 1
    v_lshl_or_b32 v67, v70, 16, v67
    s_lshl_b32 s67, s45, 7
    s_add_u32 s67, s67, 77824
    s_add_u32 s60, s42, s67
    s_addc_u32 s61, s43, 0
    s_mov_b32 s65, 0
.sg_100:
    s_load_dwordx16 s[80:95], s[60:61], 0 glc
    s_waitcnt lgkmcnt(0)
    s_cmp_lg_u32 s80, s44
    s_cbranch_scc1 .sgrt_102
    s_cmp_lg_u32 s81, s44
    s_cbranch_scc1 .sgrt_102
    s_cmp_lg_u32 s82, s44
    s_cbranch_scc1 .sgrt_102
    s_cmp_lg_u32 s83, s44
    s_cbranch_scc1 .sgrt_102
    s_cmp_lg_u32 s84, s44
    s_cbranch_scc1 .sgrt_102
    s_cmp_lg_u32 s85, s44
    s_cbranch_scc1 .sgrt_102
    s_cmp_lg_u32 s86, s44
    s_cbranch_scc1 .sgrt_102
    s_cmp_lg_u32 s87, s44
    s_cbranch_scc1 .sgrt_102
    s_cmp_lg_u32 s88, s44
    s_cbranch_scc1 .sgrt_102
    s_cmp_lg_u32 s89, s44
    s_cbranch_scc1 .sgrt_102
    s_cmp_lg_u32 s90, s44
    s_cbranch_scc1 .sgrt_102
    s_cmp_lg_u32 s91, s44
    s_cbranch_scc1 .sgrt_102
    s_cmp_lg_u32 s92, s44
    s_cbranch_scc1 .sgrt_102
    s_cmp_lg_u32 s93, s44
    s_cbranch_scc1 .sgrt_102
    s_cmp_lg_u32 s94, s44
    s_cbranch_scc1 .sgrt_102
    s_cmp_lg_u32 s95, s44
    s_cbranch_scc1 .sgrt_102
    s_branch .sgok_101
.sgrt_102:
    s_sleep 3
    s_add_u32 s65, s65, 1
    s_cmp_lt_u32 s65, 4000
    s_cbranch_scc1 .sg_100
.sgok_101:
.h3p_103:
    buffer_load_dwordx4 v[48:51], v32, s[48:51], s64 offen sc1
    buffer_load_dwordx4 v[52:55], v32, s[48:51], s64 offen offset:16 sc1
    buffer_load_dwordx4 v[80:83], v34, s[48:51], s66 offen offset:0 sc1
    buffer_load_dwordx4 v[84:87], v34, s[48:51], s66 offen offset:128 sc1
    buffer_load_dwordx4 v[88:91], v34, s[48:51], s66 offen offset:256 sc1
    buffer_load_dwordx4 v[92:95], v34, s[48:51], s66 offen offset:384 sc1
    buffer_load_dwordx4 v[96:99], v34, s[48:51], s66 offen offset:512 sc1
    buffer_load_dwordx4 v[100:103], v34, s[48:51], s66 offen offset:640 sc1
    buffer_load_dwordx4 v[104:107], v34, s[48:51], s66 offen offset:768 sc1
    buffer_load_dwordx4 v[108:111], v34, s[48:51], s66 offen offset:896 sc1
    buffer_load_dwordx4 v[112:115], v34, s[48:51], s66 offen offset:1024 sc1
    buffer_load_dwordx4 v[116:119], v34, s[48:51], s66 offen offset:1152 sc1
    buffer_load_dwordx4 v[120:123], v34, s[48:51], s66 offen offset:1280 sc1
    buffer_load_dwordx4 v[124:127], v34, s[48:51], s66 offen offset:1408 sc1
    buffer_load_dwordx4 v[128:131], v34, s[48:51], s66 offen offset:1536 sc1
    buffer_load_dwordx4 v[132:135], v34, s[48:51], s66 offen offset:1664 sc1
    buffer_load_dwordx4 v[136:139], v34, s[48:51], s66 offen offset:1792 sc1
    buffer_load_dwordx4 v[140:143], v34, s[48:51], s66 offen offset:1920 sc1
    v_mov_b32 v47, 152608
    v_mov_b32 v46, 1
    ds_write_b32 v47, v46
    v_mov_b32 v47, 152576
.wf_104:
    ds_read_b32 v46, v47
    s_waitcnt lgkmcnt(0)
    v_readfirstlane_b32 s65, v46
    s_nop 1
    s_cmp_ge_u32 s65, 13
    s_cbranch_scc1 .wfok_105
    s_add_u32 s47, s47, 1
    s_cmp_lt_u32 s47, 2000000
    s_cbranch_scc1 .wf_104
    s_branch .Lend
.wfok_105:
    v_lshlrev_b32 v45, 4, v1
    v_add_u32 v45, 65536, v45
    ds_read_b128 v[144:147], v45 offset:0
    ds_read_b128 v[148:151], v45 offset:1024
    ds_read_b128 v[152:155], v45 offset:2048
    ds_read_b128 v[156:159], v45 offset:3072
    ds_read_b128 v[160:163], v45 offset:4096
    ds_read_b128 v[164:167], v45 offset:5120
    ds_read_b128 v[168:171], v45 offset:6144
    ds_read_b128 v[172:175], v45 offset:7168
    ds_read_b128 v[176:179], v45 offset:8192
    ds_read_b128 v[180:183], v45 offset:9216
    ds_read_b128 v[184:187], v45 offset:10240
    ds_read_b128 v[188:191], v45 offset:11264
    s_waitcnt lgkmcnt(4)
    ds_read_b128 v[192:195], v45 offset:12288
    ds_read_b128 v[196:199], v45 offset:13312
    ds_read_b128 v[200:203], v45 offset:14336
    ds_read_b128 v[204:207], v45 offset:15360
    s_waitcnt vmcnt(16)
    v_xor_b32 v33, s44, v49
    v_bitop3_b32 v33, v33, v51, s44 bitop3:0xf6
    v_bitop3_b32 v33, v33, v53, s44 bitop3:0xf6
    v_bitop3_b32 v33, v33, v55, s44 bitop3:0xf6
    v_cmp_ne_u32 vcc, 0, v33
    s_nop 1
    s_cbranch_vccz .h3sok_107
    s_waitcnt vmcnt(0)
    s_sleep 1
    s_add_u32 s47, s47, 1
    s_cmp_lt_u32 s47, 2000000
    s_cbranch_scc1 .h3p_103
    s_branch .Lend
.h3sok_107:
    v_max_f32 v56, v48, v52
    s_nop 1
    v_max_f32_dpp v56, v56, v56 quad_perm:[1,0,3,2] row_mask:0xf bank_mask:0xf
    s_nop 1
    v_max_f32_dpp v56, v56, v56 quad_perm:[2,3,0,1] row_mask:0xf bank_mask:0xf
    s_nop 1
    v_max_f32_dpp v56, v56, v56 row_half_mirror row_mask:0xf bank_mask:0xf

    v_mov_b32 v57, v56
    s_nop 1
    v_permlane16_swap_b32 v56, v57
    s_nop 1
    v_max_f32 v56, v56, v57
    v_mov_b32 v57, v56
    s_nop 1
    v_permlane32_swap_b32 v56, v57
    s_nop 1
    v_max_f32 v56, v56, v57
    v_sub_f32 v58, v48, v56
    v_sub_f32 v59, v52, v56
    v_exp_f32 v58, v58
    v_exp_f32 v59, v59
    s_nop 0
    v_cvt_pk_bf16_f32 v60, v58, v59
    v_mul_f32 v61, v58, v50
    v_fmac_f32 v61, v59, v54
    v_lshrrev_b32 v62, 3, v2
    v_lshlrev_b32 v62, 7, v62
    v_lshl_add_u32 v62, v3, 5, v62
    v_and_b32 v63, 7, v2
    v_lshl_add_u32 v62, v63, 2, v62
    v_add_u32 v62, 152832, v62
    ds_write_b32 v62, v60

    v_lshrrev_b32 v45, 3, v2
    v_lshlrev_b32 v45, 7, v45
    v_lshl_add_u32 v45, v3, 5, v45
    v_add_u32 v45, 152832, v45
    s_waitcnt lgkmcnt(0)
    ds_read_b128 v[208:211], v45
    ds_read_b128 v[212:215], v45 offset:16
    s_waitcnt lgkmcnt(0)
    v_add_f32_dpp v61, v61, v61 quad_perm:[1,0,3,2] row_mask:0xf bank_mask:0xf
    s_nop 1
    v_add_f32_dpp v61, v61, v61 quad_perm:[2,3,0,1] row_mask:0xf bank_mask:0xf
    s_nop 1
    v_add_f32_dpp v61, v61, v61 row_half_mirror row_mask:0xf bank_mask:0xf

    v_mov_b32 v57, v61
    s_nop 1
    v_permlane16_swap_b32 v61, v57
    s_nop 1
    v_add_f32 v61, v61, v57
    v_mov_b32 v57, v61
    s_nop 1
    v_permlane32_swap_b32 v61, v57
    s_nop 1
    v_add_f32 v61, v61, v57
    v_rcp_f32 v61, v61
    v_mov_b32 v63, 0
    s_mov_b32 s68, 0xfffefffe
    v_perm_b32 v216, v208, v208, v4
    v_perm_b32 v217, v208, v208, v5
    v_perm_b32 v218, v208, v208, v6
    v_perm_b32 v219, v208, v208, v7
    s_waitcnt vmcnt(15)
    v_bitop3_b32 v63, v63, v80, v64 bitop3:0xf6
    v_bitop3_b32 v63, v63, v81, v65 bitop3:0xf6
    v_bitop3_b32 v63, v63, v82, v66 bitop3:0xf6
    v_bitop3_b32 v63, v63, v83, v67 bitop3:0xf6
    v_and_b32 v80, s68, v80
    v_and_b32 v81, s68, v81
    v_and_b32 v82, s68, v82
    v_and_b32 v83, s68, v83
    v_perm_b32 v220, v208, v208, v8
    v_perm_b32 v221, v208, v208, v9
    v_perm_b32 v222, v208, v208, v10
    v_perm_b32 v223, v208, v208, v11
    v_mfma_f32_16x16x32_bf16 v[240:243], v[216:219], v[80:83], 0
    s_waitcnt vmcnt(14)
    v_bitop3_b32 v63, v63, v84, v64 bitop3:0xf6
    v_bitop3_b32 v63, v63, v85, v65 bitop3:0xf6
    v_bitop3_b32 v63, v63, v86, v66 bitop3:0xf6
    v_bitop3_b32 v63, v63, v87, v67 bitop3:0xf6
    v_and_b32 v84, s68, v84
    v_and_b32 v85, s68, v85
    v_and_b32 v86, s68, v86
    v_and_b32 v87, s68, v87
    v_perm_b32 v216, v209, v209, v4
    v_perm_b32 v217, v209, v209, v5
    v_perm_b32 v218, v209, v209, v6
    v_perm_b32 v219, v209, v209, v7
    v_mfma_f32_16x16x32_bf16 v[240:243], v[220:223], v[84:87], v[240:243]
    s_waitcnt vmcnt(13)
    v_bitop3_b32 v63, v63, v88, v64 bitop3:0xf6
    v_bitop3_b32 v63, v63, v89, v65 bitop3:0xf6
    v_bitop3_b32 v63, v63, v90, v66 bitop3:0xf6
    v_bitop3_b32 v63, v63, v91, v67 bitop3:0xf6
    v_and_b32 v88, s68, v88
    v_and_b32 v89, s68, v89
    v_and_b32 v90, s68, v90
    v_and_b32 v91, s68, v91
    v_perm_b32 v220, v209, v209, v8
    v_perm_b32 v221, v209, v209, v9
    v_perm_b32 v222, v209, v209, v10
    v_perm_b32 v223, v209, v209, v11
    v_mfma_f32_16x16x32_bf16 v[240:243], v[216:219], v[88:91], v[240:243]
    s_waitcnt vmcnt(12)
    v_bitop3_b32 v63, v63, v92, v64 bitop3:0xf6
    v_bitop3_b32 v63, v63, v93, v65 bitop3:0xf6
    v_bitop3_b32 v63, v63, v94, v66 bitop3:0xf6
    v_bitop3_b32 v63, v63, v95, v67 bitop3:0xf6
    v_and_b32 v92, s68, v92
    v_and_b32 v93, s68, v93
    v_and_b32 v94, s68, v94
    v_and_b32 v95, s68, v95
    v_perm_b32 v216, v210, v210, v4
    v_perm_b32 v217, v210, v210, v5
    v_perm_b32 v218, v210, v210, v6
    v_perm_b32 v219, v210, v210, v7
    v_mfma_f32_16x16x32_bf16 v[240:243], v[220:223], v[92:95], v[240:243]
    s_waitcnt vmcnt(11)
    v_bitop3_b32 v63, v63, v96, v64 bitop3:0xf6
    v_bitop3_b32 v63, v63, v97, v65 bitop3:0xf6
    v_bitop3_b32 v63, v63, v98, v66 bitop3:0xf6
    v_bitop3_b32 v63, v63, v99, v67 bitop3:0xf6
    v_and_b32 v96, s68, v96
    v_and_b32 v97, s68, v97
    v_and_b32 v98, s68, v98
    v_and_b32 v99, s68, v99
    v_perm_b32 v220, v210, v210, v8
    v_perm_b32 v221, v210, v210, v9
    v_perm_b32 v222, v210, v210, v10
    v_perm_b32 v223, v210, v210, v11
    v_mfma_f32_16x16x32_bf16 v[240:243], v[216:219], v[96:99], v[240:243]
    s_waitcnt vmcnt(10)
    v_bitop3_b32 v63, v63, v100, v64 bitop3:0xf6
    v_bitop3_b32 v63, v63, v101, v65 bitop3:0xf6
    v_bitop3_b32 v63, v63, v102, v66 bitop3:0xf6
    v_bitop3_b32 v63, v63, v103, v67 bitop3:0xf6
    v_and_b32 v100, s68, v100
    v_and_b32 v101, s68, v101
    v_and_b32 v102, s68, v102
    v_and_b32 v103, s68, v103
    v_perm_b32 v216, v211, v211, v4
    v_perm_b32 v217, v211, v211, v5
    v_perm_b32 v218, v211, v211, v6
    v_perm_b32 v219, v211, v211, v7
    v_mfma_f32_16x16x32_bf16 v[240:243], v[220:223], v[100:103], v[240:243]
    s_waitcnt vmcnt(9)
    v_bitop3_b32 v63, v63, v104, v64 bitop3:0xf6
    v_bitop3_b32 v63, v63, v105, v65 bitop3:0xf6
    v_bitop3_b32 v63, v63, v106, v66 bitop3:0xf6
    v_bitop3_b32 v63, v63, v107, v67 bitop3:0xf6
    v_and_b32 v104, s68, v104
    v_and_b32 v105, s68, v105
    v_and_b32 v106, s68, v106
    v_and_b32 v107, s68, v107
    v_perm_b32 v220, v211, v211, v8
    v_perm_b32 v221, v211, v211, v9
    v_perm_b32 v222, v211, v211, v10
    v_perm_b32 v223, v211, v211, v11
    v_mfma_f32_16x16x32_bf16 v[240:243], v[216:219], v[104:107], v[240:243]
    s_waitcnt vmcnt(8)
    v_bitop3_b32 v63, v63, v108, v64 bitop3:0xf6
    v_bitop3_b32 v63, v63, v109, v65 bitop3:0xf6
    v_bitop3_b32 v63, v63, v110, v66 bitop3:0xf6
    v_bitop3_b32 v63, v63, v111, v67 bitop3:0xf6
    v_and_b32 v108, s68, v108
    v_and_b32 v109, s68, v109
    v_and_b32 v110, s68, v110
    v_and_b32 v111, s68, v111
    v_perm_b32 v216, v212, v212, v4
    v_perm_b32 v217, v212, v212, v5
    v_perm_b32 v218, v212, v212, v6
    v_perm_b32 v219, v212, v212, v7
    v_mfma_f32_16x16x32_bf16 v[240:243], v[220:223], v[108:111], v[240:243]
    s_waitcnt vmcnt(7)
    v_bitop3_b32 v63, v63, v112, v64 bitop3:0xf6
    v_bitop3_b32 v63, v63, v113, v65 bitop3:0xf6
    v_bitop3_b32 v63, v63, v114, v66 bitop3:0xf6
    v_bitop3_b32 v63, v63, v115, v67 bitop3:0xf6
    v_and_b32 v112, s68, v112
    v_and_b32 v113, s68, v113
    v_and_b32 v114, s68, v114
    v_and_b32 v115, s68, v115
    v_perm_b32 v220, v212, v212, v8
    v_perm_b32 v221, v212, v212, v9
    v_perm_b32 v222, v212, v212, v10
    v_perm_b32 v223, v212, v212, v11
    v_mfma_f32_16x16x32_bf16 v[240:243], v[216:219], v[112:115], v[240:243]
    s_waitcnt vmcnt(6)
    v_bitop3_b32 v63, v63, v116, v64 bitop3:0xf6
    v_bitop3_b32 v63, v63, v117, v65 bitop3:0xf6
    v_bitop3_b32 v63, v63, v118, v66 bitop3:0xf6
    v_bitop3_b32 v63, v63, v119, v67 bitop3:0xf6
    v_and_b32 v116, s68, v116
    v_and_b32 v117, s68, v117
    v_and_b32 v118, s68, v118
    v_and_b32 v119, s68, v119
    v_perm_b32 v216, v213, v213, v4
    v_perm_b32 v217, v213, v213, v5
    v_perm_b32 v218, v213, v213, v6
    v_perm_b32 v219, v213, v213, v7
    v_mfma_f32_16x16x32_bf16 v[240:243], v[220:223], v[116:119], v[240:243]
    s_waitcnt vmcnt(5)
    v_bitop3_b32 v63, v63, v120, v64 bitop3:0xf6
    v_bitop3_b32 v63, v63, v121, v65 bitop3:0xf6
    v_bitop3_b32 v63, v63, v122, v66 bitop3:0xf6
    v_bitop3_b32 v63, v63, v123, v67 bitop3:0xf6
    v_and_b32 v120, s68, v120
    v_and_b32 v121, s68, v121
    v_and_b32 v122, s68, v122
    v_and_b32 v123, s68, v123
    v_perm_b32 v220, v213, v213, v8
    v_perm_b32 v221, v213, v213, v9
    v_perm_b32 v222, v213, v213, v10
    v_perm_b32 v223, v213, v213, v11
    v_mfma_f32_16x16x32_bf16 v[240:243], v[216:219], v[120:123], v[240:243]
    s_waitcnt vmcnt(4)
    v_bitop3_b32 v63, v63, v124, v64 bitop3:0xf6
    v_bitop3_b32 v63, v63, v125, v65 bitop3:0xf6
    v_bitop3_b32 v63, v63, v126, v66 bitop3:0xf6
    v_bitop3_b32 v63, v63, v127, v67 bitop3:0xf6
    v_and_b32 v124, s68, v124
    v_and_b32 v125, s68, v125
    v_and_b32 v126, s68, v126
    v_and_b32 v127, s68, v127
    v_perm_b32 v216, v214, v214, v4
    v_perm_b32 v217, v214, v214, v5
    v_perm_b32 v218, v214, v214, v6
    v_perm_b32 v219, v214, v214, v7
    v_mfma_f32_16x16x32_bf16 v[240:243], v[220:223], v[124:127], v[240:243]
    s_waitcnt vmcnt(3)
    v_bitop3_b32 v63, v63, v128, v64 bitop3:0xf6
    v_bitop3_b32 v63, v63, v129, v65 bitop3:0xf6
    v_bitop3_b32 v63, v63, v130, v66 bitop3:0xf6
    v_bitop3_b32 v63, v63, v131, v67 bitop3:0xf6
    v_and_b32 v128, s68, v128
    v_and_b32 v129, s68, v129
    v_and_b32 v130, s68, v130
    v_and_b32 v131, s68, v131
    v_perm_b32 v220, v214, v214, v8
    v_perm_b32 v221, v214, v214, v9
    v_perm_b32 v222, v214, v214, v10
    v_perm_b32 v223, v214, v214, v11
    v_mfma_f32_16x16x32_bf16 v[240:243], v[216:219], v[128:131], v[240:243]
    s_waitcnt vmcnt(2)
    v_bitop3_b32 v63, v63, v132, v64 bitop3:0xf6
    v_bitop3_b32 v63, v63, v133, v65 bitop3:0xf6
    v_bitop3_b32 v63, v63, v134, v66 bitop3:0xf6
    v_bitop3_b32 v63, v63, v135, v67 bitop3:0xf6
    v_and_b32 v132, s68, v132
    v_and_b32 v133, s68, v133
    v_and_b32 v134, s68, v134
    v_and_b32 v135, s68, v135
    v_perm_b32 v216, v215, v215, v4
    v_perm_b32 v217, v215, v215, v5
    v_perm_b32 v218, v215, v215, v6
    v_perm_b32 v219, v215, v215, v7
    v_mfma_f32_16x16x32_bf16 v[240:243], v[220:223], v[132:135], v[240:243]
    s_waitcnt vmcnt(1)
    v_bitop3_b32 v63, v63, v136, v64 bitop3:0xf6
    v_bitop3_b32 v63, v63, v137, v65 bitop3:0xf6
    v_bitop3_b32 v63, v63, v138, v66 bitop3:0xf6
    v_bitop3_b32 v63, v63, v139, v67 bitop3:0xf6
    v_and_b32 v136, s68, v136
    v_and_b32 v137, s68, v137
    v_and_b32 v138, s68, v138
    v_and_b32 v139, s68, v139
    v_perm_b32 v220, v215, v215, v8
    v_perm_b32 v221, v215, v215, v9
    v_perm_b32 v222, v215, v215, v10
    v_perm_b32 v223, v215, v215, v11
    v_mfma_f32_16x16x32_bf16 v[240:243], v[216:219], v[136:139], v[240:243]
    s_waitcnt vmcnt(0)
    v_bitop3_b32 v63, v63, v140, v64 bitop3:0xf6
    v_bitop3_b32 v63, v63, v141, v65 bitop3:0xf6
    v_bitop3_b32 v63, v63, v142, v66 bitop3:0xf6
    v_bitop3_b32 v63, v63, v143, v67 bitop3:0xf6
    v_and_b32 v140, s68, v140
    v_and_b32 v141, s68, v141
    v_and_b32 v142, s68, v142
    v_and_b32 v143, s68, v143
    s_nop 1
    v_mfma_f32_16x16x32_bf16 v[240:243], v[220:223], v[140:143], v[240:243]
    v_and_b32 v63, 0x00010001, v63
    v_cmp_ne_u32 vcc, 0, v63
    s_nop 1
    s_cbranch_vccz .h3ok_108
    s_add_u32 s47, s47, 1
    s_cmp_lt_u32 s47, 2000000
    s_cbranch_scc1 .h3p_103
    s_branch .Lend
.h3ok_108:
    v_mov_b32 v47, 152596
    v_mov_b32 v46, 1
    ds_write_b32 v47, v46
    v_mul_f32 v240, v61, v240
    v_mul_f32 v241, v61, v241
    v_mul_f32 v242, v61, v242
    v_mul_f32 v243, v61, v243
    v_cvt_pk_bf16_f32 v36, v240, v241
    v_cvt_pk_bf16_f32 v37, v242, v243
    v_and_b32 v62, 3, v2
    v_and_b32 v57, 1, v3
    v_xor_b32 v63, v62, v57
    v_and_b32 v63, 1, v63
    v_lshlrev_b32 v63, 3, v63
    v_lshl_add_u32 v63, v62, 5, v63
    v_bfe_u32 v62, v2, 2, 1
    v_lshl_add_u32 v63, v62, 4, v63
    v_lshrrev_b32 v62, 3, v2
    v_lshl_add_u32 v63, v62, 7, v63
    v_add_u32 v63, 152832, v63
    v_lshrrev_b32 v57, 1, v3
    v_cmp_eq_u32 vcc, v57, v62
    s_and_saveexec_b64 s[70:71], vcc
    ds_write_b64 v63, v[36:37]
    s_mov_b64 exec, s[70:71]

    v_lshrrev_b32 v45, 3, v2
    v_lshlrev_b32 v45, 7, v45
    v_lshl_add_u32 v45, v3, 5, v45
    v_add_u32 v45, 152832, v45
    s_waitcnt lgkmcnt(0)
    ds_read_b128 v[208:211], v45
    ds_read_b128 v[212:215], v45 offset:16
    s_waitcnt lgkmcnt(0)
    v_perm_b32 v216, v208, v208, v4
    v_perm_b32 v217, v208, v208, v5
    v_perm_b32 v218, v208, v208, v6
    v_perm_b32 v219, v208, v208, v7
    v_perm_b32 v220, v208, v208, v8
    v_perm_b32 v221, v208, v208, v9
    v_perm_b32 v222, v208, v208, v10
    v_perm_b32 v223, v208, v208, v11
    v_mfma_f32_16x16x32_bf16 v[240:243], v[216:219], v[144:147], 0
    v_perm_b32 v216, v209, v209, v4
    v_perm_b32 v217, v209, v209, v5
    v_perm_b32 v218, v209, v209, v6
    v_perm_b32 v219, v209, v209, v7
    v_mfma_f32_16x16x32_bf16 v[240:243], v[220:223], v[148:151], v[240:243]
    v_perm_b32 v220, v209, v209, v8
    v_perm_b32 v221, v209, v209, v9
    v_perm_b32 v222, v209, v209, v10
    v_perm_b32 v223, v209, v209, v11
    v_mfma_f32_16x16x32_bf16 v[240:243], v[216:219], v[152:155], v[240:243]
    v_perm_b32 v216, v210, v210, v4
    v_perm_b32 v217, v210, v210, v5
    v_perm_b32 v218, v210, v210, v6
    v_perm_b32 v219, v210, v210, v7
    v_mfma_f32_16x16x32_bf16 v[240:243], v[220:223], v[156:159], v[240:243]
    v_perm_b32 v220, v210, v210, v8
    v_perm_b32 v221, v210, v210, v9
    v_perm_b32 v222, v210, v210, v10
    v_perm_b32 v223, v210, v210, v11
    v_mfma_f32_16x16x32_bf16 v[240:243], v[216:219], v[160:163], v[240:243]
    v_perm_b32 v216, v211, v211, v4
    v_perm_b32 v217, v211, v211, v5
    v_perm_b32 v218, v211, v211, v6
    v_perm_b32 v219, v211, v211, v7
    v_mfma_f32_16x16x32_bf16 v[240:243], v[220:223], v[164:167], v[240:243]
    v_perm_b32 v220, v211, v211, v8
    v_perm_b32 v221, v211, v211, v9
    v_perm_b32 v222, v211, v211, v10
    v_perm_b32 v223, v211, v211, v11
    v_mfma_f32_16x16x32_bf16 v[240:243], v[216:219], v[168:171], v[240:243]
    v_perm_b32 v216, v212, v212, v4
    v_perm_b32 v217, v212, v212, v5
    v_perm_b32 v218, v212, v212, v6
    v_perm_b32 v219, v212, v212, v7
    v_mfma_f32_16x16x32_bf16 v[240:243], v[220:223], v[172:175], v[240:243]
    v_perm_b32 v220, v212, v212, v8
    v_perm_b32 v221, v212, v212, v9
    v_perm_b32 v222, v212, v212, v10
    v_perm_b32 v223, v212, v212, v11
    v_mfma_f32_16x16x32_bf16 v[240:243], v[216:219], v[176:179], v[240:243]
    v_perm_b32 v216, v213, v213, v4
    v_perm_b32 v217, v213, v213, v5
    v_perm_b32 v218, v213, v213, v6
    v_perm_b32 v219, v213, v213, v7
    v_mfma_f32_16x16x32_bf16 v[240:243], v[220:223], v[180:183], v[240:243]
    v_perm_b32 v220, v213, v213, v8
    v_perm_b32 v221, v213, v213, v9
    v_perm_b32 v222, v213, v213, v10
    v_perm_b32 v223, v213, v213, v11
    v_mfma_f32_16x16x32_bf16 v[240:243], v[216:219], v[184:187], v[240:243]
    v_perm_b32 v216, v214, v214, v4
    v_perm_b32 v217, v214, v214, v5
    v_perm_b32 v218, v214, v214, v6
    v_perm_b32 v219, v214, v214, v7
    v_mfma_f32_16x16x32_bf16 v[240:243], v[220:223], v[188:191], v[240:243]
    v_perm_b32 v220, v214, v214, v8
    v_perm_b32 v221, v214, v214, v9
    v_perm_b32 v222, v214, v214, v10
    v_perm_b32 v223, v214, v214, v11
    v_mfma_f32_16x16x32_bf16 v[240:243], v[216:219], v[192:195], v[240:243]
    v_perm_b32 v216, v215, v215, v4
    v_perm_b32 v217, v215, v215, v5
    v_perm_b32 v218, v215, v215, v6
    v_perm_b32 v219, v215, v215, v7
    v_mfma_f32_16x16x32_bf16 v[240:243], v[220:223], v[196:199], v[240:243]
    v_perm_b32 v220, v215, v215, v8
    v_perm_b32 v221, v215, v215, v9
    v_perm_b32 v222, v215, v215, v10
    v_perm_b32 v223, v215, v215, v11
    v_mfma_f32_16x16x32_bf16 v[240:243], v[216:219], v[200:203], v[240:243]
    s_nop 1
    v_mfma_f32_16x16x32_bf16 v[240:243], v[220:223], v[204:207], v[240:243]
    v_lshrrev_b32 v40, 1, v3
    v_lshlrev_b32 v40, 9, v40
    v_lshl_add_u32 v40, v2, 5, v40
    v_and_b32 v41, 1, v3
    v_lshl_add_u32 v40, v41, 4, v40
    s_lshl_b32 s64, s45, 3
    s_add_u32 s64, s64, s46
    s_lshl_b32 s64, s64, 10
    s_add_u32 s64, s64, 1048576
    s_nop 7
    s_nop 1
    v_cvt_pk_bf16_f32 v36, v240, v241
    v_cvt_pk_bf16_f32 v38, v242, v243
    v_mov_b32 v37, s44
    v_mov_b32 v39, s44
    s_add_u32 s69, s64, 8388608
    buffer_store_dwordx4 v[36:39], v40, s[48:51], s69 offen
    buffer_store_dwordx4 v[36:39], v40, s[48:51], s64 offen sc1
    v_lshlrev_b32 v32, 10, v3
    v_lshl_add_u32 v32, v2, 4, v32
    s_lshl_b32 s64, s45, 13
    s_lshr_b32 s65, s46, 2
    s_lshl_b32 s66, s65, 8
    s_add_u32 s64, s64, s66
    s_add_u32 s64, s64, 1048576
    s_add_u32 s66, s64, 4096

    v_and_b32 v48, 0x3f803f80, v12
    v_and_b32 v49, 0x3f803f80, v13
    v_and_b32 v50, 0x3f803f80, v14
    v_and_b32 v51, 0x3f803f80, v15
    v_mov_b32 v47, 152576
.wf_109:
    ds_read_b32 v46, v47
    s_waitcnt lgkmcnt(0)
    v_readfirstlane_b32 s65, v46
    s_nop 1
    s_cmp_ge_u32 s65, 15
    s_cbranch_scc1 .wfok_110
    s_add_u32 s47, s47, 1
    s_cmp_lt_u32 s47, 2000000
    s_cbranch_scc1 .wf_109
    s_branch .Lend
.wfok_110:
    v_lshlrev_b32 v45, 4, v1
    v_add_u32 v45, 81920, v45
    ds_read_b128 v[144:147], v45 offset:0
    ds_read_b128 v[148:151], v45 offset:1024
    ds_read_b128 v[152:155], v45 offset:2048
    ds_read_b128 v[156:159], v45 offset:3072
    ds_read_b128 v[160:163], v45 offset:4096
    ds_read_b128 v[164:167], v45 offset:5120
    ds_read_b128 v[168:171], v45 offset:6144
    ds_read_b128 v[172:175], v45 offset:7168
    ds_read_b128 v[176:179], v45 offset:8192
    ds_read_b128 v[180:183], v45 offset:9216
    ds_read_b128 v[184:187], v45 offset:10240
    ds_read_b128 v[188:191], v45 offset:11264
    s_waitcnt lgkmcnt(4)
    ds_read_b128 v[192:195], v45 offset:12288
    ds_read_b128 v[196:199], v45 offset:13312
    ds_read_b128 v[200:203], v45 offset:14336
    ds_read_b128 v[204:207], v45 offset:15360
    s_add_u32 s64, s64, 8388608
    s_add_u32 s66, s66, 8388608
    s_mov_b32 s69, 0
.h4_111:
    buffer_load_dwordx4 v[80:83], v32, s[48:51], s64 offen offset:0 sc1
    buffer_load_dwordx4 v[84:87], v32, s[48:51], s66 offen offset:0 sc1
    buffer_load_dwordx4 v[88:91], v32, s[48:51], s64 offen offset:512 sc1
    buffer_load_dwordx4 v[92:95], v32, s[48:51], s66 offen offset:512 sc1
    s_waitcnt vmcnt(0)
    v_xor_b32 v33, s44, v81
    v_bitop3_b32 v33, v33, v83, s44 bitop3:0xf6
    v_bitop3_b32 v33, v33, v85, s44 bitop3:0xf6
    v_bitop3_b32 v33, v33, v87, s44 bitop3:0xf6
    v_bitop3_b32 v33, v33, v89, s44 bitop3:0xf6
    v_bitop3_b32 v33, v33, v91, s44 bitop3:0xf6
    v_bitop3_b32 v33, v33, v93, s44 bitop3:0xf6
    v_bitop3_b32 v33, v33, v95, s44 bitop3:0xf6
    v_cmp_ne_u32 vcc, 0, v33
    s_nop 1
    s_cbranch_vccz .tok_112
    s_add_u32 s69, s69, 1
    s_cmp_lg_u32 s69, 6
    s_cbranch_scc1 .psw_113
    s_sub_u32 s64, s64, 8388608
    s_sub_u32 s66, s66, 8388608
.psw_113:
    s_add_u32 s47, s47, 1
    s_cmp_lt_u32 s47, 2000000
    s_cbranch_scc1 .h4_111
    s_branch .Lend
.tok_112:
    v_mov_b32 v81, v82
    v_mov_b32 v85, v86
    v_mov_b32 v89, v90
    v_mov_b32 v93, v94
    s_nop 1
    v_mfma_f32_16x16x16_bf16 v[240:243], v[48:49], v[80:81], 0
    v_mfma_f32_16x16x16_bf16 v[240:243], v[48:49], v[84:85], v[240:243]
    v_mfma_f32_16x16x16_bf16 v[240:243], v[50:51], v[88:89], v[240:243]
    v_mfma_f32_16x16x16_bf16 v[240:243], v[50:51], v[92:93], v[240:243]
    v_lshlrev_b32 v38, 7, v3
    v_lshl_add_u32 v38, v2, 3, v38
    v_add_u32 v38, 152832, v38
    v_cmp_gt_u32 vcc, 32, v1
    s_nop 4
    v_cvt_pk_bf16_f32 v36, v240, v241
    v_cvt_pk_bf16_f32 v37, v242, v243
    s_and_saveexec_b64 s[70:71], vcc
    ds_write_b64 v38, v[36:37]
    s_mov_b64 exec, s[70:71]

    v_lshrrev_b32 v45, 3, v2
    v_lshlrev_b32 v45, 7, v45
    v_lshl_add_u32 v45, v3, 5, v45
    v_add_u32 v45, 152832, v45
    s_waitcnt lgkmcnt(0)
    ds_read_b128 v[208:211], v45
    ds_read_b128 v[212:215], v45 offset:16
    s_waitcnt lgkmcnt(0)
    v_perm_b32 v216, v208, v208, v4
    v_perm_b32 v217, v208, v208, v5
    v_perm_b32 v218, v208, v208, v6
    v_perm_b32 v219, v208, v208, v7
    v_perm_b32 v220, v208, v208, v8
    v_perm_b32 v221, v208, v208, v9
    v_perm_b32 v222, v208, v208, v10
    v_perm_b32 v223, v208, v208, v11
    v_mfma_f32_16x16x32_bf16 v[240:243], v[216:219], v[144:147], 0
    v_perm_b32 v216, v209, v209, v4
    v_perm_b32 v217, v209, v209, v5
    v_perm_b32 v218, v209, v209, v6
    v_perm_b32 v219, v209, v209, v7
    v_mfma_f32_16x16x32_bf16 v[240:243], v[220:223], v[148:151], v[240:243]
    v_perm_b32 v220, v209, v209, v8
    v_perm_b32 v221, v209, v209, v9
    v_perm_b32 v222, v209, v209, v10
    v_perm_b32 v223, v209, v209, v11
    v_mfma_f32_16x16x32_bf16 v[240:243], v[216:219], v[152:155], v[240:243]
    v_perm_b32 v216, v210, v210, v4
    v_perm_b32 v217, v210, v210, v5
    v_perm_b32 v218, v210, v210, v6
    v_perm_b32 v219, v210, v210, v7
    v_mfma_f32_16x16x32_bf16 v[240:243], v[220:223], v[156:159], v[240:243]
    v_perm_b32 v220, v210, v210, v8
    v_perm_b32 v221, v210, v210, v9
    v_perm_b32 v222, v210, v210, v10
    v_perm_b32 v223, v210, v210, v11
    v_mfma_f32_16x16x32_bf16 v[240:243], v[216:219], v[160:163], v[240:243]
    v_perm_b32 v216, v211, v211, v4
    v_perm_b32 v217, v211, v211, v5
    v_perm_b32 v218, v211, v211, v6
    v_perm_b32 v219, v211, v211, v7
    v_mfma_f32_16x16x32_bf16 v[240:243], v[220:223], v[164:167], v[240:243]
    v_perm_b32 v220, v211, v211, v8
    v_perm_b32 v221, v211, v211, v9
    v_perm_b32 v222, v211, v211, v10
    v_perm_b32 v223, v211, v211, v11
    v_mfma_f32_16x16x32_bf16 v[240:243], v[216:219], v[168:171], v[240:243]
    v_perm_b32 v216, v212, v212, v4
    v_perm_b32 v217, v212, v212, v5
    v_perm_b32 v218, v212, v212, v6
    v_perm_b32 v219, v212, v212, v7
    v_mfma_f32_16x16x32_bf16 v[240:243], v[220:223], v[172:175], v[240:243]
    v_perm_b32 v220, v212, v212, v8
    v_perm_b32 v221, v212, v212, v9
    v_perm_b32 v222, v212, v212, v10
    v_perm_b32 v223, v212, v212, v11
    v_mfma_f32_16x16x32_bf16 v[240:243], v[216:219], v[176:179], v[240:243]
    v_perm_b32 v216, v213, v213, v4
    v_perm_b32 v217, v213, v213, v5
    v_perm_b32 v218, v213, v213, v6
    v_perm_b32 v219, v213, v213, v7
    v_mfma_f32_16x16x32_bf16 v[240:243], v[220:223], v[180:183], v[240:243]
    v_perm_b32 v220, v213, v213, v8
    v_perm_b32 v221, v213, v213, v9
    v_perm_b32 v222, v213, v213, v10
    v_perm_b32 v223, v213, v213, v11
    v_mfma_f32_16x16x32_bf16 v[240:243], v[216:219], v[184:187], v[240:243]
    v_perm_b32 v216, v214, v214, v4
    v_perm_b32 v217, v214, v214, v5
    v_perm_b32 v218, v214, v214, v6
    v_perm_b32 v219, v214, v214, v7
    v_mfma_f32_16x16x32_bf16 v[240:243], v[220:223], v[188:191], v[240:243]
    v_perm_b32 v220, v214, v214, v8
    v_perm_b32 v221, v214, v214, v9
    v_perm_b32 v222, v214, v214, v10
    v_perm_b32 v223, v214, v214, v11
    v_mfma_f32_16x16x32_bf16 v[240:243], v[216:219], v[192:195], v[240:243]
    v_perm_b32 v216, v215, v215, v4
    v_perm_b32 v217, v215, v215, v5
    v_perm_b32 v218, v215, v215, v6
    v_perm_b32 v219, v215, v215, v7
    v_mfma_f32_16x16x32_bf16 v[240:243], v[220:223], v[196:199], v[240:243]
    v_perm_b32 v220, v215, v215, v8
    v_perm_b32 v221, v215, v215, v9
    v_perm_b32 v222, v215, v215, v10
    v_perm_b32 v223, v215, v215, v11
    v_mfma_f32_16x16x32_bf16 v[240:243], v[216:219], v[200:203], v[240:243]
    s_nop 1
    v_mfma_f32_16x16x32_bf16 v[240:243], v[220:223], v[204:207], v[240:243]
    s_lshl_b32 s67, s45, 1
    s_lshr_b32 s65, s46, 2
    s_add_u32 s67, s67, s65
    v_lshrrev_b32 v40, 2, v1
    v_lshlrev_b32 v40, 12, v40
    v_and_b32 v41, 3, v1
    v_lshl_add_u32 v40, v41, 4, v40
    s_and_b32 s64, s46, 3
    s_add_u32 s64, s64, 0
    s_lshl_b32 s64, s64, 16
    s_lshl_b32 s65, s67, 6
    s_add_u32 s64, s64, s65
    s_add_u32 s64, s64, 2097152
    s_nop 7
    s_nop 1
    v_cvt_pk_bf16_f32 v36, v240, v241
    v_cvt_pk_bf16_f32 v38, v242, v243
    v_mov_b32 v37, s44
    v_mov_b32 v39, s44
    buffer_store_dwordx4 v[36:39], v40, s[48:51], s64 offen sc1
    s_and_b32 s64, s46, 3
    s_add_u32 s64, s64, 0
    s_lshl_b32 s64, s64, 8
    s_lshr_b32 s65, s67, 2
    s_lshl_b32 s65, s65, 2
    s_add_u32 s64, s64, s65
    s_add_u32 s64, s64, 86016
    s_and_b32 s65, s67, 3

    s_cmp_eq_u32 s65, 1
    s_cbranch_scc0 .pf_114
    v_lshlrev_b32 v47, 7, v1
    v_mov_b32 v46, s44
    s_mov_b64 exec, 3
    buffer_store_dword v46, v47, s[48:51], s64 offen sc1
    s_mov_b64 exec, -1
.pf_114:
    s_branch .Lend
.Lt1:
    s_and_b32 s72, s2, 7
    s_lshl_b32 s72, s72, 2
    s_bfe_u32 s73, s2, 0x20003
    s_add_u32 s72, s72, s73
    s_lshr_b32 s73, s46, 2
    v_and_b32 v32, 3, v2
    v_lshlrev_b32 v32, 6, v32
    v_lshl_add_u32 v32, v3, 4, v32
    s_lshl_b32 s64, s72, 8
    s_add_u32 s64, s64, 1835008
    s_add_u32 s68, s64, 8192
    v_lshlrev_b32 v34, 9, v3
    v_lshl_add_u32 v34, v2, 4, v34
    s_lshl_b32 s66, s72, 13
    s_lshl_b32 s67, s73, 8
    s_add_u32 s66, s66, s67
    s_add_u32 s66, s66, 1310720

    s_and_b32 s67, s2, 7
    s_lshl_b32 s67, s67, 2
    s_lshr_b32 s65, s46, 1
    s_add_u32 s67, s67, s65
    s_lshl_b32 s67, s67, 7
    s_add_u32 s67, s67, 81920
    s_add_u32 s60, s42, s67
    s_addc_u32 s61, s43, 0
    s_mov_b32 s65, 0
.sg_115:
    s_load_dwordx16 s[80:95], s[60:61], 0 glc
    s_waitcnt lgkmcnt(0)
    s_cmp_lg_u32 s80, s44
    s_cbranch_scc1 .sgrt_117
    s_cmp_lg_u32 s81, s44
    s_cbranch_scc1 .sgrt_117
    s_cmp_lg_u32 s82, s44
    s_cbranch_scc1 .sgrt_117
    s_cmp_lg_u32 s83, s44
    s_cbranch_scc1 .sgrt_117
    s_cmp_lg_u32 s84, s44
    s_cbranch_scc1 .sgrt_117
    s_cmp_lg_u32 s85, s44
    s_cbranch_scc1 .sgrt_117
    s_cmp_lg_u32 s86, s44
    s_cbranch_scc1 .sgrt_117
    s_cmp_lg_u32 s87, s44
    s_cbranch_scc1 .sgrt_117
    s_cmp_lg_u32 s88, s44
    s_cbranch_scc1 .sgrt_117
    s_cmp_lg_u32 s89, s44
    s_cbranch_scc1 .sgrt_117
    s_cmp_lg_u32 s90, s44
    s_cbranch_scc1 .sgrt_117
    s_cmp_lg_u32 s91, s44
    s_cbranch_scc1 .sgrt_117
    s_cmp_lg_u32 s92, s44
    s_cbranch_scc1 .sgrt_117
    s_cmp_lg_u32 s93, s44
    s_cbranch_scc1 .sgrt_117
    s_cmp_lg_u32 s94, s44
    s_cbranch_scc1 .sgrt_117
    s_cmp_lg_u32 s95, s44
    s_cbranch_scc1 .sgrt_117
    s_branch .sgok_116
.sgrt_117:
    s_sleep 3
    s_add_u32 s65, s65, 1
    s_cmp_lt_u32 s65, 4000
    s_cbranch_scc1 .sg_115
.sgok_116:
.h3b_118:
    buffer_load_dwordx4 v[48:51], v32, s[48:51], s64 offen sc1
    buffer_load_dwordx4 v[52:55], v32, s[48:51], s68 offen sc1
    s_add_u32 s67, s66, 0
    buffer_load_dwordx4 v[80:83], v34, s[48:51], s67 offen offset:0 sc1
    s_add_u32 s67, s66, 0
    buffer_load_dwordx4 v[84:87], v34, s[48:51], s67 offen offset:2048 sc1
    s_add_u32 s67, s66, 4096
    buffer_load_dwordx4 v[88:91], v34, s[48:51], s67 offen offset:0 sc1
    s_add_u32 s67, s66, 4096
    buffer_load_dwordx4 v[92:95], v34, s[48:51], s67 offen offset:2048 sc1
    s_add_u32 s67, s66, 262144
    buffer_load_dwordx4 v[96:99], v34, s[48:51], s67 offen offset:0 sc1
    s_add_u32 s67, s66, 262144
    buffer_load_dwordx4 v[100:103], v34, s[48:51], s67 offen offset:2048 sc1
    s_add_u32 s67, s66, 266240
    buffer_load_dwordx4 v[104:107], v34, s[48:51], s67 offen offset:0 sc1
    s_add_u32 s67, s66, 266240
    buffer_load_dwordx4 v[108:111], v34, s[48:51], s67 offen offset:2048 sc1
    s_waitcnt vmcnt(8)
    v_mov_b32 v60, v48
    s_nop 1
    v_max_f32_dpp v60, v60, v60 quad_perm:[1,0,3,2] row_mask:0xf bank_mask:0xf
    s_nop 1
    v_max_f32_dpp v60, v60, v60 quad_perm:[2,3,0,1] row_mask:0xf bank_mask:0xf
    v_mov_b32 v61, v60
    s_nop 1
    v_permlane16_swap_b32 v60, v61
    s_nop 1
    v_max_f32 v60, v60, v61
    v_mov_b32 v61, v60
    s_nop 1
    v_permlane32_swap_b32 v60, v61
    s_nop 1
    v_max_f32 v60, v60, v61
    v_sub_f32 v56, v48, v60
    v_exp_f32 v56, v56
    s_nop 0
    v_mul_f32 v58, v56, v50
    s_nop 1
    v_add_f32_dpp v58, v58, v58 quad_perm:[1,0,3,2] row_mask:0xf bank_mask:0xf
    s_nop 1
    v_add_f32_dpp v58, v58, v58 quad_perm:[2,3,0,1] row_mask:0xf bank_mask:0xf
    v_mov_b32 v61, v58
    s_nop 1
    v_permlane16_swap_b32 v58, v61
    s_nop 1
    v_add_f32 v58, v58, v61
    v_mov_b32 v61, v58
    s_nop 1
    v_permlane32_swap_b32 v58, v61
    s_nop 1
    v_add_f32 v58, v58, v61
    v_cvt_pk_bf16_f32 v56, v56, v56
    v_mov_b32 v60, v52
    s_nop 1
    v_max_f32_dpp v60, v60, v60 quad_perm:[1,0,3,2] row_mask:0xf bank_mask:0xf
    s_nop 1
    v_max_f32_dpp v60, v60, v60 quad_perm:[2,3,0,1] row_mask:0xf bank_mask:0xf
    v_mov_b32 v61, v60
    s_nop 1
    v_permlane16_swap_b32 v60, v61
    s_nop 1
    v_max_f32 v60, v60, v61
    v_mov_b32 v61, v60
    s_nop 1
    v_permlane32_swap_b32 v60, v61
    s_nop 1
    v_max_f32 v60, v60, v61
    v_sub_f32 v57, v52, v60
    v_exp_f32 v57, v57
    s_nop 0
    v_mul_f32 v59, v57, v54
    s_nop 1
    v_add_f32_dpp v59, v59, v59 quad_perm:[1,0,3,2] row_mask:0xf bank_mask:0xf
    s_nop 1
    v_add_f32_dpp v59, v59, v59 quad_perm:[2,3,0,1] row_mask:0xf bank_mask:0xf
    v_mov_b32 v61, v59
    s_nop 1
    v_permlane16_swap_b32 v59, v61
    s_nop 1
    v_add_f32 v59, v59, v61
    v_mov_b32 v61, v59
    s_nop 1
    v_permlane32_swap_b32 v59, v61
    s_nop 1
    v_add_f32 v59, v59, v61
    v_cvt_pk_bf16_f32 v57, v57, v57
    s_waitcnt vmcnt(0)
    v_xor_b32 v33, s44, v49
    v_bitop3_b32 v33, v33, v51, s44 bitop3:0xf6
    v_bitop3_b32 v33, v33, v53, s44 bitop3:0xf6
    v_bitop3_b32 v33, v33, v55, s44 bitop3:0xf6
    v_bitop3_b32 v33, v33, v81, s44 bitop3:0xf6
    v_bitop3_b32 v33, v33, v83, s44 bitop3:0xf6
    v_bitop3_b32 v33, v33, v85, s44 bitop3:0xf6
    v_bitop3_b32 v33, v33, v87, s44 bitop3:0xf6
    v_bitop3_b32 v33, v33, v89, s44 bitop3:0xf6
    v_bitop3_b32 v33, v33, v91, s44 bitop3:0xf6
    v_bitop3_b32 v33, v33, v93, s44 bitop3:0xf6
    v_bitop3_b32 v33, v33, v95, s44 bitop3:0xf6
    v_bitop3_b32 v33, v33, v97, s44 bitop3:0xf6
    v_bitop3_b32 v33, v33, v99, s44 bitop3:0xf6
    v_bitop3_b32 v33, v33, v101, s44 bitop3:0xf6
    v_bitop3_b32 v33, v33, v103, s44 bitop3:0xf6
    v_bitop3_b32 v33, v33, v105, s44 bitop3:0xf6
    v_bitop3_b32 v33, v33, v107, s44 bitop3:0xf6
    v_bitop3_b32 v33, v33, v109, s44 bitop3:0xf6
    v_bitop3_b32 v33, v33, v111, s44 bitop3:0xf6
    v_cmp_ne_u32 vcc, 0, v33
    s_nop 1
    s_cbranch_vccz .tok_119
    s_sleep 2
    s_add_u32 s47, s47, 1
    s_cmp_lt_u32 s47, 2000000
    s_cbranch_scc1 .h3b_118
    s_branch .Lend
.tok_119:
    v_mov_b32 v81, v82
    v_mov_b32 v85, v86
    v_mov_b32 v89, v90
    v_mov_b32 v93, v94
    v_mov_b32 v97, v98
    v_mov_b32 v101, v102
    v_mov_b32 v105, v106
    v_mov_b32 v109, v110
    v_mov_b32_dpp v62, v56 quad_perm:[0,0,0,0] row_mask:0xf bank_mask:0xf
    s_nop 0
    v_and_b32 v216, v62, v12
    v_and_b32 v217, v62, v13
    s_nop 1
    v_mfma_f32_16x16x16_bf16 v[240:243], v[216:217], v[80:81], 0
    v_mov_b32_dpp v62, v56 quad_perm:[1,1,1,1] row_mask:0xf bank_mask:0xf
    s_nop 0
    v_and_b32 v218, v62, v12
    v_and_b32 v219, v62, v13
    s_nop 1
    v_mfma_f32_16x16x16_bf16 v[240:243], v[218:219], v[84:85], v[240:243]
    v_mov_b32_dpp v62, v56 quad_perm:[2,2,2,2] row_mask:0xf bank_mask:0xf
    s_nop 0
    v_and_b32 v216, v62, v12
    v_and_b32 v217, v62, v13
    s_nop 1
    v_mfma_f32_16x16x16_bf16 v[240:243], v[216:217], v[88:89], v[240:243]
    v_mov_b32_dpp v62, v56 quad_perm:[3,3,3,3] row_mask:0xf bank_mask:0xf
    s_nop 0
    v_and_b32 v218, v62, v12
    v_and_b32 v219, v62, v13
    s_nop 1
    v_mfma_f32_16x16x16_bf16 v[240:243], v[218:219], v[92:93], v[240:243]
    v_mov_b32_dpp v62, v57 quad_perm:[0,0,0,0] row_mask:0xf bank_mask:0xf
    s_nop 0
    v_and_b32 v216, v62, v14
    v_and_b32 v217, v62, v15
    s_nop 1
    v_mfma_f32_16x16x16_bf16 v[240:243], v[216:217], v[96:97], v[240:243]
    v_mov_b32_dpp v62, v57 quad_perm:[1,1,1,1] row_mask:0xf bank_mask:0xf
    s_nop 0
    v_and_b32 v218, v62, v14
    v_and_b32 v219, v62, v15
    s_nop 1
    v_mfma_f32_16x16x16_bf16 v[240:243], v[218:219], v[100:101], v[240:243]
    v_mov_b32_dpp v62, v57 quad_perm:[2,2,2,2] row_mask:0xf bank_mask:0xf
    s_nop 0
    v_and_b32 v216, v62, v14
    v_and_b32 v217, v62, v15
    s_nop 1
    v_mfma_f32_16x16x16_bf16 v[240:243], v[216:217], v[104:105], v[240:243]
    v_mov_b32_dpp v62, v57 quad_perm:[3,3,3,3] row_mask:0xf bank_mask:0xf
    s_nop 0
    v_and_b32 v218, v62, v14
    v_and_b32 v219, v62, v15
    s_nop 1
    v_mfma_f32_16x16x16_bf16 v[240:243], v[218:219], v[108:109], v[240:243]
    v_cmp_eq_u32 vcc, 1, v3
    s_nop 1
    v_cndmask_b32 v58, v58, v59, vcc
    v_rcp_f32 v58, v58
    s_nop 7

    v_mul_f32 v240, v58, v240
    v_mul_f32 v241, v58, v241
    v_mul_f32 v242, v58, v242
    v_mul_f32 v243, v58, v243
    v_cvt_pk_bf16_f32 v36, v240, v241
    v_cvt_pk_bf16_f32 v37, v242, v243
    v_lshlrev_b32 v38, 7, v3
    v_lshl_add_u32 v38, v2, 3, v38
    v_add_u32 v38, 153088, v38
    v_cmp_gt_u32 vcc, 32, v1
    s_and_saveexec_b64 s[70:71], vcc
    ds_write_b64 v38, v[36:37]
    s_mov_b64 exec, s[70:71]

    v_mov_b32 v47, 152576
.wf_120:
    ds_read_b32 v46, v47
    s_waitcnt lgkmcnt(0)
    v_readfirstlane_b32 s65, v46
    s_nop 1
    s_cmp_ge_u32 s65, 14
    s_cbranch_scc1 .wfok_121
    s_sleep 1
    s_add_u32 s47, s47, 1
    s_cmp_lt_u32 s47, 2000000
    s_cbranch_scc1 .wf_120
    s_branch .Lend
.wfok_121:
    v_lshlrev_b32 v45, 4, v1
    v_add_u32 v45, 98304, v45
    ds_read_b128 v[144:147], v45 offset:0
    ds_read_b128 v[148:151], v45 offset:1024
    ds_read_b128 v[152:155], v45 offset:2048
    ds_read_b128 v[156:159], v45 offset:3072
    ds_read_b128 v[160:163], v45 offset:4096
    ds_read_b128 v[164:167], v45 offset:5120
    ds_read_b128 v[168:171], v45 offset:6144
    ds_read_b128 v[172:175], v45 offset:7168
    ds_read_b128 v[176:179], v45 offset:8192
    ds_read_b128 v[180:183], v45 offset:9216
    ds_read_b128 v[184:187], v45 offset:10240
    ds_read_b128 v[188:191], v45 offset:11264
    s_waitcnt lgkmcnt(4)
    ds_read_b128 v[192:195], v45 offset:12288
    ds_read_b128 v[196:199], v45 offset:13312
    ds_read_b128 v[200:203], v45 offset:14336
    ds_read_b128 v[204:207], v45 offset:15360
    v_lshrrev_b32 v45, 3, v2
    v_lshlrev_b32 v45, 7, v45
    v_lshl_add_u32 v45, v3, 5, v45
    v_add_u32 v45, 153088, v45
    s_waitcnt lgkmcnt(0)
    ds_read_b128 v[208:211], v45
    ds_read_b128 v[212:215], v45 offset:16
    s_waitcnt lgkmcnt(0)
    v_perm_b32 v216, v208, v208, v4
    v_perm_b32 v217, v208, v208, v5
    v_perm_b32 v218, v208, v208, v6
    v_perm_b32 v219, v208, v208, v7
    v_perm_b32 v220, v208, v208, v8
    v_perm_b32 v221, v208, v208, v9
    v_perm_b32 v222, v208, v208, v10
    v_perm_b32 v223, v208, v208, v11
    v_mfma_f32_16x16x32_bf16 v[240:243], v[216:219], v[144:147], 0
    v_perm_b32 v216, v209, v209, v4
    v_perm_b32 v217, v209, v209, v5
    v_perm_b32 v218, v209, v209, v6
    v_perm_b32 v219, v209, v209, v7
    v_mfma_f32_16x16x32_bf16 v[240:243], v[220:223], v[148:151], v[240:243]
    v_perm_b32 v220, v209, v209, v8
    v_perm_b32 v221, v209, v209, v9
    v_perm_b32 v222, v209, v209, v10
    v_perm_b32 v223, v209, v209, v11
    v_mfma_f32_16x16x32_bf16 v[240:243], v[216:219], v[152:155], v[240:243]
    v_perm_b32 v216, v210, v210, v4
    v_perm_b32 v217, v210, v210, v5
    v_perm_b32 v218, v210, v210, v6
    v_perm_b32 v219, v210, v210, v7
    v_mfma_f32_16x16x32_bf16 v[240:243], v[220:223], v[156:159], v[240:243]
    v_perm_b32 v220, v210, v210, v8
    v_perm_b32 v221, v210, v210, v9
    v_perm_b32 v222, v210, v210, v10
    v_perm_b32 v223, v210, v210, v11
    v_mfma_f32_16x16x32_bf16 v[240:243], v[216:219], v[160:163], v[240:243]
    v_perm_b32 v216, v211, v211, v4
    v_perm_b32 v217, v211, v211, v5
    v_perm_b32 v218, v211, v211, v6
    v_perm_b32 v219, v211, v211, v7
    v_mfma_f32_16x16x32_bf16 v[240:243], v[220:223], v[164:167], v[240:243]
    v_perm_b32 v220, v211, v211, v8
    v_perm_b32 v221, v211, v211, v9
    v_perm_b32 v222, v211, v211, v10
    v_perm_b32 v223, v211, v211, v11
    v_mfma_f32_16x16x32_bf16 v[240:243], v[216:219], v[168:171], v[240:243]
    v_perm_b32 v216, v212, v212, v4
    v_perm_b32 v217, v212, v212, v5
    v_perm_b32 v218, v212, v212, v6
    v_perm_b32 v219, v212, v212, v7
    v_mfma_f32_16x16x32_bf16 v[240:243], v[220:223], v[172:175], v[240:243]
    v_perm_b32 v220, v212, v212, v8
    v_perm_b32 v221, v212, v212, v9
    v_perm_b32 v222, v212, v212, v10
    v_perm_b32 v223, v212, v212, v11
    v_mfma_f32_16x16x32_bf16 v[240:243], v[216:219], v[176:179], v[240:243]
    v_perm_b32 v216, v213, v213, v4
    v_perm_b32 v217, v213, v213, v5
    v_perm_b32 v218, v213, v213, v6
    v_perm_b32 v219, v213, v213, v7
    v_mfma_f32_16x16x32_bf16 v[240:243], v[220:223], v[180:183], v[240:243]
    v_perm_b32 v220, v213, v213, v8
    v_perm_b32 v221, v213, v213, v9
    v_perm_b32 v222, v213, v213, v10
    v_perm_b32 v223, v213, v213, v11
    v_mfma_f32_16x16x32_bf16 v[240:243], v[216:219], v[184:187], v[240:243]
    v_perm_b32 v216, v214, v214, v4
    v_perm_b32 v217, v214, v214, v5
    v_perm_b32 v218, v214, v214, v6
    v_perm_b32 v219, v214, v214, v7
    v_mfma_f32_16x16x32_bf16 v[240:243], v[220:223], v[188:191], v[240:243]
    v_perm_b32 v220, v214, v214, v8
    v_perm_b32 v221, v214, v214, v9
    v_perm_b32 v222, v214, v214, v10
    v_perm_b32 v223, v214, v214, v11
    v_mfma_f32_16x16x32_bf16 v[240:243], v[216:219], v[192:195], v[240:243]
    v_perm_b32 v216, v215, v215, v4
    v_perm_b32 v217, v215, v215, v5
    v_perm_b32 v218, v215, v215, v6
    v_perm_b32 v219, v215, v215, v7
    v_mfma_f32_16x16x32_bf16 v[240:243], v[220:223], v[196:199], v[240:243]
    v_perm_b32 v220, v215, v215, v8
    v_perm_b32 v221, v215, v215, v9
    v_perm_b32 v222, v215, v215, v10
    v_perm_b32 v223, v215, v215, v11
    v_mfma_f32_16x16x32_bf16 v[240:243], v[216:219], v[200:203], v[240:243]
    s_nop 1
    v_mfma_f32_16x16x32_bf16 v[240:243], v[220:223], v[204:207], v[240:243]
    s_lshl_b32 s67, s72, 1
    s_add_u32 s67, s67, s73
    v_lshrrev_b32 v40, 2, v1
    v_lshlrev_b32 v40, 12, v40
    v_and_b32 v41, 3, v1
    v_lshl_add_u32 v40, v41, 4, v40
    s_and_b32 s64, s46, 3
    s_add_u32 s64, s64, 4
    s_lshl_b32 s64, s64, 16
    s_lshl_b32 s65, s67, 6
    s_add_u32 s64, s64, s65
    s_add_u32 s64, s64, 2097152
    s_nop 7
    s_nop 1
    v_cvt_pk_bf16_f32 v36, v240, v241
    v_cvt_pk_bf16_f32 v38, v242, v243
    v_mov_b32 v37, s44
    v_mov_b32 v39, s44
    buffer_store_dwordx4 v[36:39], v40, s[48:51], s64 offen sc1
    s_and_b32 s64, s46, 3
    s_add_u32 s64, s64, 4
    s_lshl_b32 s64, s64, 8
    s_lshr_b32 s65, s67, 2
    s_lshl_b32 s65, s65, 2
    s_add_u32 s64, s64, s65
    s_add_u32 s64, s64, 86016
    s_and_b32 s65, s67, 3

    s_cmp_eq_u32 s65, 1
    s_cbranch_scc0 .pf_122
    v_lshlrev_b32 v47, 7, v1
    v_mov_b32 v46, s44
    s_mov_b64 exec, 3
    buffer_store_dword v46, v47, s[48:51], s64 offen sc1
    s_mov_b64 exec, -1
.pf_122:
    s_branch .Lend
.Lt2:
    v_lshlrev_b32 v68, 4, v1
    v_lshlrev_b32 v69, 17, v3
    v_lshl_add_u32 v69, v2, 4, v69
    v_lshlrev_b32 v70, 14, v3
    v_lshl_add_u32 v70, v2, 4, v70
    v_mov_b32 v71, 152576

    s_waitcnt vmcnt(17)
    v_mov_b32 v246, 9
    ds_write_b32 v71, v246 offset:0
    s_mov_b32 s52, s32
    s_mov_b32 s53, s33
    s_mov_b32 s54, 33554432
    s_mov_b32 s55, 0x00020000
    s_mov_b32 m0, 40960
    s_add_u32 s67, s77, 8192
    buffer_load_dwordx4 v68, s[52:55], s67 offen nt lds
    s_waitcnt vmcnt(17)
    s_mov_b32 m0, 41984
    s_add_u32 s67, s77, 9216
    buffer_load_dwordx4 v68, s[52:55], s67 offen nt lds
    s_waitcnt vmcnt(17)
    s_mov_b32 m0, 43008
    s_add_u32 s67, s77, 10240
    buffer_load_dwordx4 v68, s[52:55], s67 offen nt lds
    s_waitcnt vmcnt(17)
    s_mov_b32 m0, 44032
    s_add_u32 s67, s77, 11264
    buffer_load_dwordx4 v68, s[52:55], s67 offen nt lds
    s_waitcnt vmcnt(17)
    s_mov_b32 m0, 45056
    s_add_u32 s67, s77, 12288
    buffer_load_dwordx4 v68, s[52:55], s67 offen nt lds
    s_waitcnt vmcnt(17)
    s_mov_b32 m0, 46080
    s_add_u32 s67, s77, 13312
    buffer_load_dwordx4 v68, s[52:55], s67 offen nt lds
    s_waitcnt vmcnt(17)
    s_mov_b32 m0, 47104
    s_add_u32 s67, s77, 14336
    buffer_load_dwordx4 v68, s[52:55], s67 offen nt lds
    s_waitcnt vmcnt(17)
    v_mov_b32 v246, 10
    ds_write_b32 v71, v246 offset:0
    s_mov_b32 m0, 48128
    s_add_u32 s67, s77, 15360
    buffer_load_dwordx4 v68, s[52:55], s67 offen nt lds
    s_waitcnt vmcnt(17)
    s_mov_b32 m0, 49152
    s_add_u32 s67, s77, 16384
    buffer_load_dwordx4 v68, s[52:55], s67 offen nt lds
    s_waitcnt vmcnt(17)
    s_mov_b32 m0, 50176
    s_add_u32 s67, s77, 17408
    buffer_load_dwordx4 v68, s[52:55], s67 offen nt lds
    s_waitcnt vmcnt(17)
    s_mov_b32 m0, 51200
    s_add_u32 s67, s77, 18432
    buffer_load_dwordx4 v68, s[52:55], s67 offen nt lds
    s_waitcnt vmcnt(17)
    s_mov_b32 m0, 52224
    s_add_u32 s67, s77, 19456
    buffer_load_dwordx4 v68, s[52:55], s67 offen nt lds
    s_waitcnt vmcnt(17)
    s_mov_b32 m0, 53248
    s_add_u32 s67, s77, 20480
    buffer_load_dwordx4 v68, s[52:55], s67 offen nt lds
    s_waitcnt vmcnt(17)
    s_mov_b32 m0, 54272
    s_add_u32 s67, s77, 21504
    buffer_load_dwordx4 v68, s[52:55], s67 offen nt lds
    s_waitcnt vmcnt(17)
    s_mov_b32 m0, 55296
    s_add_u32 s67, s77, 22528
    buffer_load_dwordx4 v68, s[52:55], s67 offen nt lds
    s_waitcnt vmcnt(17)
    s_mov_b32 m0, 56320
    s_add_u32 s67, s77, 23552
    buffer_load_dwordx4 v68, s[52:55], s67 offen nt lds
    s_waitcnt vmcnt(15)
    s_mov_b32 m0, 57344
    s_add_u32 s67, s77, 24576
    buffer_load_dwordx4 v68, s[52:55], s67 offen nt lds
    s_waitcnt vmcnt(15)
    s_mov_b32 m0, 58368
    s_add_u32 s67, s77, 25600
    buffer_load_dwordx4 v68, s[52:55], s67 offen nt lds
    s_waitcnt vmcnt(15)
    s_mov_b32 m0, 59392
    s_add_u32 s67, s77, 26624
    buffer_load_dwordx4 v68, s[52:55], s67 offen nt lds
    s_waitcnt vmcnt(15)
    s_mov_b32 m0, 60416
    s_add_u32 s67, s77, 27648
    buffer_load_dwordx4 v68, s[52:55], s67 offen nt lds
    s_waitcnt vmcnt(15)
    s_mov_b32 m0, 61440
    s_add_u32 s67, s77, 28672
    buffer_load_dwordx4 v68, s[52:55], s67 offen nt lds
    s_waitcnt vmcnt(15)
    s_mov_b32 m0, 62464
    s_add_u32 s67, s77, 29696
    buffer_load_dwordx4 v68, s[52:55], s67 offen nt lds
    s_waitcnt vmcnt(15)
    s_mov_b32 m0, 63488
    s_add_u32 s67, s77, 30720
    buffer_load_dwordx4 v68, s[52:55], s67 offen nt lds
    s_waitcnt vmcnt(15)
    v_mov_b32 v246, 11
    ds_write_b32 v71, v246 offset:0
    s_mov_b32 m0, 64512
    s_add_u32 s67, s77, 31744
    buffer_load_dwordx4 v68, s[52:55], s67 offen nt lds
    v_mov_b32 v47, 152644
.wf_123:
    ds_read_b32 v46, v47
    s_waitcnt lgkmcnt(0)
    v_readfirstlane_b32 s65, v46
    s_nop 1
    s_cmp_ge_u32 s65, 8
    s_cbranch_scc1 .wfok_124
    s_add_u32 s47, s47, 1
    s_cmp_lt_u32 s47, 2000000
    s_cbranch_scc1 .wf_123
    s_branch .Lend
.wfok_124:
    s_waitcnt vmcnt(15)
    s_mov_b32 s52, s24
    s_mov_b32 s53, s25
    s_mov_b32 s54, 4194304
    s_mov_b32 s55, 0x00020000
    s_mov_b32 m0, 65536
    s_add_u32 s67, s78, 0
    buffer_load_dwordx4 v69, s[52:55], s67 offen nt lds
    s_waitcnt vmcnt(15)
    s_mov_b32 m0, 66560
    s_add_u32 s67, s78, 8192
    buffer_load_dwordx4 v69, s[52:55], s67 offen nt lds
    s_waitcnt vmcnt(15)
    s_mov_b32 m0, 67584
    s_add_u32 s67, s78, 16384
    buffer_load_dwordx4 v69, s[52:55], s67 offen nt lds
    s_waitcnt vmcnt(15)
    s_mov_b32 m0, 68608
    s_add_u32 s67, s78, 24576
    buffer_load_dwordx4 v69, s[52:55], s67 offen nt lds
    s_waitcnt vmcnt(15)
    s_mov_b32 m0, 69632
    s_add_u32 s67, s78, 32768
    buffer_load_dwordx4 v69, s[52:55], s67 offen nt lds
    s_waitcnt vmcnt(15)
    s_mov_b32 m0, 70656
    s_add_u32 s67, s78, 40960
    buffer_load_dwordx4 v69, s[52:55], s67 offen nt lds
    s_waitcnt vmcnt(15)
    s_mov_b32 m0, 71680
    s_add_u32 s67, s78, 49152
    buffer_load_dwordx4 v69, s[52:55], s67 offen nt lds
    s_waitcnt vmcnt(15)
    s_mov_b32 m0, 72704
    s_add_u32 s67, s78, 57344
    buffer_load_dwordx4 v69, s[52:55], s67 offen nt lds
    s_waitcnt vmcnt(15)
    s_mov_b32 m0, 73728
    s_add_u32 s67, s78, 65536
    buffer_load_dwordx4 v69, s[52:55], s67 offen nt lds
    s_waitcnt vmcnt(15)
    s_mov_b32 m0, 74752
    s_add_u32 s67, s78, 73728
    buffer_load_dwordx4 v69, s[52:55], s67 offen nt lds
    s_waitcnt vmcnt(15)
    s_mov_b32 m0, 75776
    s_add_u32 s67, s78, 81920
    buffer_load_dwordx4 v69, s[52:55], s67 offen nt lds
    s_waitcnt vmcnt(15)
    s_mov_b32 m0, 76800
    s_add_u32 s67, s78, 90112
    buffer_load_dwordx4 v69, s[52:55], s67 offen nt lds
    s_waitcnt vmcnt(15)
    s_mov_b32 m0, 77824
    s_add_u32 s67, s78, 98304
    buffer_load_dwordx4 v69, s[52:55], s67 offen nt lds
    s_waitcnt vmcnt(15)
    s_mov_b32 m0, 78848
    s_add_u32 s67, s78, 106496
    buffer_load_dwordx4 v69, s[52:55], s67 offen nt lds
    s_waitcnt vmcnt(15)
    s_mov_b32 m0, 79872
    s_add_u32 s67, s78, 114688
    buffer_load_dwordx4 v69, s[52:55], s67 offen nt lds
    s_waitcnt vmcnt(15)
    v_mov_b32 v246, 12
    ds_write_b32 v71, v246 offset:0
    s_mov_b32 m0, 80896
    s_add_u32 s67, s78, 122880
    buffer_load_dwordx4 v69, s[52:55], s67 offen nt lds
    s_waitcnt vmcnt(0)
    v_mov_b32 v246, 13
    ds_write_b32 v71, v246 offset:0
    v_mov_b32 v47, 152608
.wf_125:
    ds_read_b32 v46, v47
    s_waitcnt lgkmcnt(0)
    v_readfirstlane_b32 s65, v46
    s_nop 1
    s_cmp_ge_u32 s65, 1
    s_cbranch_scc1 .wfok_126
    s_sleep 1
    s_add_u32 s47, s47, 1
    s_cmp_lt_u32 s47, 2000000
    s_cbranch_scc1 .wf_125
    s_branch .Lend
.wfok_126:
    s_mov_b32 s52, s36
    s_mov_b32 s53, s37
    s_mov_b32 s54, 4194304
    s_mov_b32 s55, 0x00020000
    s_and_b32 s68, s2, 7
    s_lshl_b32 s68, s68, 2
    s_bfe_u32 s69, s2, 0x20003
    s_add_u32 s68, s68, s69
    s_lshl_b32 s68, s68, 17
    s_lshr_b32 s69, s46, 2
    s_lshl_b32 s69, s69, 16
    s_add_u32 s68, s68, s69
    s_and_b32 s69, s46, 3
    s_lshl_b32 s69, s69, 8
    s_add_u32 s68, s68, s69
    s_mov_b32 m0, 98304
    s_add_u32 s67, s68, 0
    buffer_load_dwordx4 v70, s[52:55], s67 offen nt lds
    s_mov_b32 m0, 99328
    s_add_u32 s67, s68, 1024
    buffer_load_dwordx4 v70, s[52:55], s67 offen nt lds
    s_mov_b32 m0, 100352
    s_add_u32 s67, s68, 2048
    buffer_load_dwordx4 v70, s[52:55], s67 offen nt lds
    s_mov_b32 m0, 101376
    s_add_u32 s67, s68, 3072
    buffer_load_dwordx4 v70, s[52:55], s67 offen nt lds
    s_mov_b32 m0, 102400
    s_add_u32 s67, s68, 4096
    buffer_load_dwordx4 v70, s[52:55], s67 offen nt lds
    s_mov_b32 m0, 103424
    s_add_u32 s67, s68, 5120
    buffer_load_dwordx4 v70, s[52:55], s67 offen nt lds
    s_mov_b32 m0, 104448
    s_add_u32 s67, s68, 6144
    buffer_load_dwordx4 v70, s[52:55], s67 offen nt lds
    s_mov_b32 m0, 105472
    s_add_u32 s67, s68, 7168
    buffer_load_dwordx4 v70, s[52:55], s67 offen nt lds
    s_mov_b32 m0, 106496
    s_add_u32 s67, s68, 8192
    buffer_load_dwordx4 v70, s[52:55], s67 offen nt lds
    s_mov_b32 m0, 107520
    s_add_u32 s67, s68, 9216
    buffer_load_dwordx4 v70, s[52:55], s67 offen nt lds
    s_mov_b32 m0, 108544
    s_add_u32 s67, s68, 10240
    buffer_load_dwordx4 v70, s[52:55], s67 offen nt lds
    s_mov_b32 m0, 109568
    s_add_u32 s67, s68, 11264
    buffer_load_dwordx4 v70, s[52:55], s67 offen nt lds
    s_mov_b32 m0, 110592
    s_add_u32 s67, s68, 12288
    buffer_load_dwordx4 v70, s[52:55], s67 offen nt lds
    s_mov_b32 m0, 111616
    s_add_u32 s67, s68, 13312
    buffer_load_dwordx4 v70, s[52:55], s67 offen nt lds
    s_mov_b32 m0, 112640
    s_add_u32 s67, s68, 14336
    buffer_load_dwordx4 v70, s[52:55], s67 offen nt lds
    s_mov_b32 m0, 113664
    s_add_u32 s67, s68, 15360
    buffer_load_dwordx4 v70, s[52:55], s67 offen nt lds
    s_waitcnt vmcnt(15)
    s_mov_b32 s52, s26
    s_mov_b32 s53, s27
    s_mov_b32 s54, 4194304
    s_mov_b32 s55, 0x00020000
    s_mov_b32 m0, 81920
    s_add_u32 s67, s79, 0
    buffer_load_dwordx4 v70, s[52:55], s67 offen nt lds
    s_waitcnt vmcnt(15)
    s_mov_b32 m0, 82944
    s_add_u32 s67, s79, 1024
    buffer_load_dwordx4 v70, s[52:55], s67 offen nt lds
    s_waitcnt vmcnt(15)
    s_mov_b32 m0, 83968
    s_add_u32 s67, s79, 2048
    buffer_load_dwordx4 v70, s[52:55], s67 offen nt lds
    s_waitcnt vmcnt(15)
    s_mov_b32 m0, 84992
    s_add_u32 s67, s79, 3072
    buffer_load_dwordx4 v70, s[52:55], s67 offen nt lds
    s_waitcnt vmcnt(15)
    s_mov_b32 m0, 86016
    s_add_u32 s67, s79, 4096
    buffer_load_dwordx4 v70, s[52:55], s67 offen nt lds
    s_waitcnt vmcnt(15)
    s_mov_b32 m0, 87040
    s_add_u32 s67, s79, 5120
    buffer_load_dwordx4 v70, s[52:55], s67 offen nt lds
    s_waitcnt vmcnt(15)
    s_mov_b32 m0, 88064
    s_add_u32 s67, s79, 6144
    buffer_load_dwordx4 v70, s[52:55], s67 offen nt lds
    s_waitcnt vmcnt(15)
    s_mov_b32 m0, 89088
    s_add_u32 s67, s79, 7168
    buffer_load_dwordx4 v70, s[52:55], s67 offen nt lds
    s_waitcnt vmcnt(15)
    s_mov_b32 m0, 90112
    s_add_u32 s67, s79, 8192
    buffer_load_dwordx4 v70, s[52:55], s67 offen nt lds
    s_waitcnt vmcnt(15)
    s_mov_b32 m0, 91136
    s_add_u32 s67, s79, 9216
    buffer_load_dwordx4 v70, s[52:55], s67 offen nt lds
    s_waitcnt vmcnt(15)
    s_mov_b32 m0, 92160
    s_add_u32 s67, s79, 10240
    buffer_load_dwordx4 v70, s[52:55], s67 offen nt lds
    s_waitcnt vmcnt(15)
    s_mov_b32 m0, 93184
    s_add_u32 s67, s79, 11264
    buffer_load_dwordx4 v70, s[52:55], s67 offen nt lds
    s_waitcnt vmcnt(15)
    s_mov_b32 m0, 94208
    s_add_u32 s67, s79, 12288
    buffer_load_dwordx4 v70, s[52:55], s67 offen nt lds
    s_waitcnt vmcnt(15)
    s_mov_b32 m0, 95232
    s_add_u32 s67, s79, 13312
    buffer_load_dwordx4 v70, s[52:55], s67 offen nt lds
    s_waitcnt vmcnt(15)
    s_mov_b32 m0, 96256
    s_add_u32 s67, s79, 14336
    buffer_load_dwordx4 v70, s[52:55], s67 offen nt lds
    s_waitcnt vmcnt(15)
    v_mov_b32 v246, 14
    ds_write_b32 v71, v246 offset:0
    s_mov_b32 m0, 97280
    s_add_u32 s67, s79, 15360
    buffer_load_dwordx4 v70, s[52:55], s67 offen nt lds
    s_waitcnt vmcnt(0)
    v_mov_b32 v246, 15
    ds_write_b32 v71, v246 offset:0
    s_cmp_ge_u32 s2, 128
    s_cbranch_scc1 .Lt2end
    s_lshl_b32 s64, s2, 12
    s_add_u32 s64, s64, 2097152
    v_lshlrev_b32 v32, 6, v2
    v_lshl_add_u32 v32, v3, 4, v32

    s_lshr_b32 s67, s2, 3
    s_lshl_b32 s67, s67, 7
    s_add_u32 s67, s67, 86016
.h5_127:
    buffer_load_dwordx4 v[80:83], v32, s[48:51], s64 offen offset:0 sc1
    buffer_load_dwordx4 v[84:87], v32, s[48:51], s64 offen offset:1024 sc1
    buffer_load_dwordx4 v[88:91], v32, s[48:51], s64 offen offset:2048 sc1
    buffer_load_dwordx4 v[92:95], v32, s[48:51], s64 offen offset:3072 sc1
    s_waitcnt vmcnt(0)
    v_xor_b32 v33, s44, v81
    v_bitop3_b32 v33, v33, v83, s44 bitop3:0xf6
    v_bitop3_b32 v33, v33, v85, s44 bitop3:0xf6
    v_bitop3_b32 v33, v33, v87, s44 bitop3:0xf6
    v_bitop3_b32 v33, v33, v89, s44 bitop3:0xf6
    v_bitop3_b32 v33, v33, v91, s44 bitop3:0xf6
    v_bitop3_b32 v33, v33, v93, s44 bitop3:0xf6
    v_bitop3_b32 v33, v33, v95, s44 bitop3:0xf6
    v_cmp_ne_u32 vcc, 0, v33
    s_nop 1
    s_cbranch_vccz .tok_128
    s_sleep 1
    s_add_u32 s47, s47, 1
    s_cmp_lt_u32 s47, 2000000
    s_cbranch_scc1 .h5_127
    s_branch .Lend
.tok_128:
    v_lshlrev_b32 v36, 16, v80
    v_and_b32 v37, 0xffff0000, v80
    v_lshlrev_b32 v38, 16, v82
    v_and_b32 v39, 0xffff0000, v82
    v_mov_b32 v240, v36
    v_mov_b32 v241, v37
    v_mov_b32 v242, v38
    v_mov_b32 v243, v39
    v_lshlrev_b32 v36, 16, v84
    v_and_b32 v37, 0xffff0000, v84
    v_lshlrev_b32 v38, 16, v86
    v_and_b32 v39, 0xffff0000, v86
    v_add_f32 v240, v240, v36
    v_add_f32 v241, v241, v37
    v_add_f32 v242, v242, v38
    v_add_f32 v243, v243, v39
    v_lshlrev_b32 v36, 16, v88
    v_and_b32 v37, 0xffff0000, v88
    v_lshlrev_b32 v38, 16, v90
    v_and_b32 v39, 0xffff0000, v90
    v_add_f32 v240, v240, v36
    v_add_f32 v241, v241, v37
    v_add_f32 v242, v242, v38
    v_add_f32 v243, v243, v39
    v_lshlrev_b32 v36, 16, v92
    v_and_b32 v37, 0xffff0000, v92
    v_lshlrev_b32 v38, 16, v94
    v_and_b32 v39, 0xffff0000, v94
    v_add_f32 v240, v240, v36
    v_add_f32 v241, v241, v37
    v_add_f32 v242, v242, v38
    v_add_f32 v243, v243, v39
    s_nop 1
    v_add_f32_dpp v240, v240, v240 row_ror:8 row_mask:0xf bank_mask:0xf
    v_add_f32_dpp v241, v241, v241 row_ror:8 row_mask:0xf bank_mask:0xf
    v_add_f32_dpp v242, v242, v242 row_ror:8 row_mask:0xf bank_mask:0xf
    v_add_f32_dpp v243, v243, v243 row_ror:8 row_mask:0xf bank_mask:0xf
    s_nop 1
    v_add_f32_dpp v240, v240, v240 row_ror:4 row_mask:0xf bank_mask:0xf
    v_add_f32_dpp v241, v241, v241 row_ror:4 row_mask:0xf bank_mask:0xf
    v_add_f32_dpp v242, v242, v242 row_ror:4 row_mask:0xf bank_mask:0xf
    v_add_f32_dpp v243, v243, v243 row_ror:4 row_mask:0xf bank_mask:0xf
    s_nop 1
    v_add_f32_dpp v240, v240, v240 row_ror:2 row_mask:0xf bank_mask:0xf
    v_add_f32_dpp v241, v241, v241 row_ror:2 row_mask:0xf bank_mask:0xf
    v_add_f32_dpp v242, v242, v242 row_ror:2 row_mask:0xf bank_mask:0xf
    v_add_f32_dpp v243, v243, v243 row_ror:2 row_mask:0xf bank_mask:0xf
    s_nop 1
    v_add_f32_dpp v240, v240, v240 row_ror:1 row_mask:0xf bank_mask:0xf
    v_add_f32_dpp v241, v241, v241 row_ror:1 row_mask:0xf bank_mask:0xf
    v_add_f32_dpp v242, v242, v242 row_ror:1 row_mask:0xf bank_mask:0xf
    v_add_f32_dpp v243, v243, v243 row_ror:1 row_mask:0xf bank_mask:0xf
    v_cvt_pk_bf16_f32 v36, v240, v241
    v_cvt_pk_bf16_f32 v37, v242, v243
    s_and_b32 s65, s2, 15
    s_lshr_b32 s66, s65, 2
    s_lshr_b32 s67, s66, 1
    s_lshl_b32 s67, s67, 11
    s_lshr_b32 s68, s2, 6
    s_lshl_b32 s68, s68, 10
    s_add_u32 s67, s67, s68
    s_bfe_u32 s68, s2, 0x20004
    s_lshl_b32 s68, s68, 8
    s_add_u32 s67, s67, s68
    s_and_b32 s68, s66, 1
    s_lshl_b32 s68, s68, 3
    s_add_u32 s67, s67, s68
    s_and_b32 s68, s65, 3
    s_lshl_b32 s68, s68, 6
    s_add_u32 s67, s67, s68
    v_lshlrev_b32 v33, 4, v3

    s_mov_b32 s56, s38
    s_mov_b32 s57, s39
    s_mov_b32 s58, 4096
    s_mov_b32 s59, 0x00020000
    v_cmp_eq_u32 vcc, 0, v2
    s_and_saveexec_b64 s[70:71], vcc
    buffer_store_dwordx2 v[36:37], v33, s[56:59], s67 offen
    s_mov_b64 exec, s[70:71]
    s_cmp_lg_u32 s2, 0
    s_cbranch_scc1 .Lt2end
    v_mov_b32 v33, 0
    v_mov_b32 v34, s44
    s_mov_b64 exec, 1
    buffer_store_dword v34, v33, s[48:51], 0 offen
    s_mov_b64 exec, -1

.Lt2end:
    s_branch .Lend
.Lt3:
    v_lshlrev_b32 v32, 5, v2
    v_add_u32 v32, 152064, v32
    ds_read_b128 v[208:211], v32
    ds_read_b128 v[212:215], v32 offset:16
    s_waitcnt lgkmcnt(0)
    v_add_f32 v208, v208, v209
    v_add_f32 v210, v210, v211
    v_add_f32 v212, v212, v213
    v_add_f32 v214, v214, v215
    v_add_f32 v208, v208, v210
    v_add_f32 v212, v212, v214
    v_add_f32 v38, v208, v212
    v_mov_b32 v36, v244
    v_mov_b32 v37, s44
    v_mov_b32 v39, s44
    v_lshlrev_b32 v32, 11, v2
    s_lshl_b32 s64, s76, 15
    s_lshl_b32 s65, s74, 10
    s_add_u32 s64, s64, s65
    s_lshl_b32 s65, s75, 4
    s_add_u32 s64, s64, s65
    s_add_u32 s64, s64, 1867776
    v_cmp_gt_u32 vcc, 16, v1
    s_and_saveexec_b64 s[70:71], vcc
    buffer_store_dwordx4 v[36:39], v32, s[48:51], s64 offen sc1
    s_mov_b64 exec, s[70:71]
    s_lshl_b32 s64, s76, 11
    s_lshl_b32 s65, s74, 5
    s_add_u32 s64, s64, s65
    s_lshr_b32 s65, s75, 3
    s_lshl_b32 s65, s65, 2
    s_add_u32 s64, s64, s65
    s_add_u32 s64, s64, 77824
    s_and_b32 s65, s75, 7

    s_cmp_eq_u32 s65, 5
    s_cbranch_scc0 .pf_129
    v_lshlrev_b32 v47, 7, v1
    v_mov_b32 v46, s44
    s_mov_b64 exec, 65535
    buffer_store_dword v46, v47, s[48:51], s64 offen sc1
    s_mov_b64 exec, -1
.pf_129:
    s_branch .Lend
.Lt47:
    s_sub_u32 s72, s3, 4
    v_and_b32 v34, 1, v2
    v_and_b32 v35, 2, v2
    v_lshl_or_b32 v34, v35, 2, v34
    v_lshrrev_b32 v35, 1, v2
    v_and_b32 v35, 6, v35
    v_or_b32 v34, v34, v35
    v_xor_b32 v34, v34, v3
    v_lshlrev_b32 v34, 4, v34
    v_lshl_add_u32 v34, v2, 8, v34
    s_lshl_b32 s66, s72, 13
    v_add_u32 v34, s66, v34
    v_lshlrev_b32 v40, 11, v3
    v_lshl_add_u32 v40, v2, 4, v40
    s_add_u32 s66, s66, 32768
    v_add_u32 v40, s66, v40

    v_xor_b32 v36, 0, v34
    v_xor_b32 v37, 64, v34
    v_xor_b32 v38, 128, v34
    v_xor_b32 v39, 192, v34
    v_mov_b32 v47, 152576
.wf_130:
    ds_read_b32 v46, v47
    s_waitcnt lgkmcnt(0)
    v_readfirstlane_b32 s65, v46
    s_nop 1
    s_cmp_ge_u32 s65, 10
    s_cbranch_scc1 .wfok_131
    s_sleep 1
    s_add_u32 s47, s47, 1
    s_cmp_lt_u32 s47, 2000000
    s_cbranch_scc1 .wf_130
    s_branch .Lend
.wfok_131:
    ds_read_b128 v[48:51], v36 offset:0
    ds_read_b128 v[52:55], v37 offset:0
    ds_read_b128 v[56:59], v38 offset:0
    ds_read_b128 v[60:63], v39 offset:0
    ds_read_b128 v[64:67], v36 offset:4096
    ds_read_b128 v[68:71], v37 offset:4096
    ds_read_b128 v[72:75], v38 offset:4096
    ds_read_b128 v[76:79], v39 offset:4096
    v_mov_b32 v47, 152588
.wf_132:
    ds_read_b32 v46, v47
    s_waitcnt lgkmcnt(0)
    v_readfirstlane_b32 s65, v46
    s_nop 1
    s_cmp_ge_u32 s65, 4
    s_cbranch_scc1 .wfok_133
    s_add_u32 s47, s47, 1
    s_cmp_lt_u32 s47, 2000000
    s_cbranch_scc1 .wf_132
    s_branch .Lend
.wfok_133:
    v_and_b32 v33, 3, v2
    v_lshlrev_b32 v33, 8, v33
    v_lshl_add_u32 v33, v3, 4, v33
    v_add_u32 v33, 153600, v33
    ds_read_b128 v[112:115], v33 offset:0
    ds_read_b128 v[116:119], v33 offset:64
    ds_read_b128 v[120:123], v33 offset:128
    ds_read_b128 v[124:127], v33 offset:192
    s_waitcnt lgkmcnt(0)
    v_mfma_f32_16x16x32_bf16 v[128:131], v[48:51], v[112:115], 0
    v_mfma_f32_16x16x32_bf16 v[132:135], v[64:67], v[112:115], 0
    v_mfma_f32_16x16x32_bf16 v[128:131], v[52:55], v[116:119], v[128:131]
    v_mfma_f32_16x16x32_bf16 v[132:135], v[68:71], v[116:119], v[132:135]
    v_mfma_f32_16x16x32_bf16 v[128:131], v[56:59], v[120:123], v[128:131]
    v_mfma_f32_16x16x32_bf16 v[132:135], v[72:75], v[120:123], v[132:135]
    v_mfma_f32_16x16x32_bf16 v[128:131], v[60:63], v[124:127], v[128:131]
    v_mfma_f32_16x16x32_bf16 v[132:135], v[76:79], v[124:127], v[132:135]
    s_nop 7
    s_nop 1
    v_max3_f32 v244, v128, v129, v130
    v_max3_f32 v244, v244, v131, v132
    v_max3_f32 v244, v244, v133, v134
    v_max_f32 v244, v244, v135
    v_mov_b32 v246, v244
    s_nop 1
    v_permlane16_swap_b32 v244, v246
    s_nop 1
    v_max_f32 v244, v244, v246
    v_mov_b32 v246, v244
    s_nop 1
    v_permlane32_swap_b32 v244, v246
    s_nop 1
    v_max_f32 v244, v244, v246
    v_sub_f32 v128, v128, v244
    v_sub_f32 v129, v129, v244
    v_sub_f32 v130, v130, v244
    v_sub_f32 v131, v131, v244
    v_sub_f32 v132, v132, v244
    v_sub_f32 v133, v133, v244
    v_sub_f32 v134, v134, v244
    v_sub_f32 v135, v135, v244
    v_exp_f32 v128, v128
    v_exp_f32 v129, v129
    v_exp_f32 v130, v130
    v_exp_f32 v131, v131
    v_exp_f32 v132, v132
    v_exp_f32 v133, v133
    v_exp_f32 v134, v134
    v_exp_f32 v135, v135
    s_nop 0
    v_add_f32 v245, v128, v129
    v_add_f32 v246, v130, v131
    v_add_f32 v247, v132, v133
    v_add_f32 v248, v134, v135
    v_add_f32 v245, v245, v246
    v_add_f32 v247, v247, v248
    v_add_f32 v245, v245, v247
    v_cvt_pk_bf16_f32 v248, v128, v129
    v_cvt_pk_bf16_f32 v249, v130, v131
    v_cvt_pk_bf16_f32 v250, v132, v133
    v_cvt_pk_bf16_f32 v251, v134, v135
    s_lshl_b32 s65, s72, 8
    s_add_u32 s65, s65, 154624
    v_lshlrev_b32 v33, 6, v2
    v_lshl_add_u32 v33, v3, 3, v33
    v_add_u32 v33, s65, v33
    v_cmp_gt_u32 vcc, 4, v2
    s_and_saveexec_b64 s[70:71], vcc
    ds_write_b64 v33, v[248:249]
    ds_write_b64 v33, v[250:251] offset:32
    s_mov_b64 exec, s[70:71]

    v_mov_b32 v246, v245
    s_nop 1
    v_permlane16_swap_b32 v245, v246
    s_nop 1
    v_add_f32 v245, v245, v246
    v_mov_b32 v246, v245
    s_nop 1
    v_permlane32_swap_b32 v245, v246
    s_nop 1
    v_add_f32 v245, v245, v246
    v_lshrrev_b32 v33, 3, v2
    v_lshlrev_b32 v33, 6, v33
    v_lshl_add_u32 v33, v3, 4, v33
    v_add_u32 v33, s65, v33
    s_waitcnt lgkmcnt(0)
    ds_read_b128 v[208:211], v33
    ds_read_b128 v[212:215], v33 offset:128
    s_waitcnt lgkmcnt(0)

    v_mov_b32 v47, 152576
.wf_134:
    ds_read_b32 v46, v47
    s_waitcnt lgkmcnt(0)
    v_readfirstlane_b32 s65, v46
    s_nop 1
    s_cmp_ge_u32 s65, 12
    s_cbranch_scc1 .wfok_135
    s_sleep 1
    s_add_u32 s47, s47, 1
    s_cmp_lt_u32 s47, 2000000
    s_cbranch_scc1 .wf_134
    s_branch .Lend
.wfok_135:
    ds_read_b128 v[176:179], v40 offset:0
    ds_read_b128 v[180:183], v40 offset:256
    ds_read_b128 v[184:187], v40 offset:512
    ds_read_b128 v[188:191], v40 offset:768
    ds_read_b128 v[192:195], v40 offset:1024
    ds_read_b128 v[196:199], v40 offset:1280
    ds_read_b128 v[200:203], v40 offset:1536
    ds_read_b128 v[204:207], v40 offset:1792
    v_perm_b32 v216, v208, v208, v4
    v_perm_b32 v217, v208, v208, v5
    v_perm_b32 v218, v208, v208, v6
    v_perm_b32 v219, v208, v208, v7
    v_perm_b32 v220, v212, v212, v4
    v_perm_b32 v221, v212, v212, v5
    v_perm_b32 v222, v212, v212, v6
    v_perm_b32 v223, v212, v212, v7
    s_waitcnt lgkmcnt(7)
    s_nop 1
    v_mfma_f32_16x16x32_bf16 v[80:83], v[216:219], v[176:179], 0
    v_perm_b32 v224, v208, v208, v8
    v_perm_b32 v225, v208, v208, v9
    v_perm_b32 v226, v208, v208, v10
    v_perm_b32 v227, v208, v208, v11
    v_mfma_f32_16x16x32_bf16 v[84:87], v[220:223], v[176:179], 0
    v_perm_b32 v228, v212, v212, v8
    v_perm_b32 v229, v212, v212, v9
    v_perm_b32 v230, v212, v212, v10
    v_perm_b32 v231, v212, v212, v11
    s_waitcnt lgkmcnt(6)
    v_mfma_f32_16x16x32_bf16 v[80:83], v[224:227], v[180:183], v[80:83]
    v_perm_b32 v216, v209, v209, v4
    v_perm_b32 v217, v209, v209, v5
    v_perm_b32 v218, v209, v209, v6
    v_perm_b32 v219, v209, v209, v7
    v_mfma_f32_16x16x32_bf16 v[84:87], v[228:231], v[180:183], v[84:87]
    v_perm_b32 v220, v213, v213, v4
    v_perm_b32 v221, v213, v213, v5
    v_perm_b32 v222, v213, v213, v6
    v_perm_b32 v223, v213, v213, v7
    s_waitcnt lgkmcnt(5)
    v_mfma_f32_16x16x32_bf16 v[80:83], v[216:219], v[184:187], v[80:83]
    v_perm_b32 v224, v209, v209, v8
    v_perm_b32 v225, v209, v209, v9
    v_perm_b32 v226, v209, v209, v10
    v_perm_b32 v227, v209, v209, v11
    v_mfma_f32_16x16x32_bf16 v[84:87], v[220:223], v[184:187], v[84:87]
    v_perm_b32 v228, v213, v213, v8
    v_perm_b32 v229, v213, v213, v9
    v_perm_b32 v230, v213, v213, v10
    v_perm_b32 v231, v213, v213, v11
    s_waitcnt lgkmcnt(4)
    v_mfma_f32_16x16x32_bf16 v[80:83], v[224:227], v[188:191], v[80:83]
    v_perm_b32 v216, v210, v210, v4
    v_perm_b32 v217, v210, v210, v5
    v_perm_b32 v218, v210, v210, v6
    v_perm_b32 v219, v210, v210, v7
    v_mfma_f32_16x16x32_bf16 v[84:87], v[228:231], v[188:191], v[84:87]
    v_perm_b32 v220, v214, v214, v4
    v_perm_b32 v221, v214, v214, v5
    v_perm_b32 v222, v214, v214, v6
    v_perm_b32 v223, v214, v214, v7
    s_waitcnt lgkmcnt(3)
    v_mfma_f32_16x16x32_bf16 v[80:83], v[216:219], v[192:195], v[80:83]
    v_perm_b32 v224, v210, v210, v8
    v_perm_b32 v225, v210, v210, v9
    v_perm_b32 v226, v210, v210, v10
    v_perm_b32 v227, v210, v210, v11
    v_mfma_f32_16x16x32_bf16 v[84:87], v[220:223], v[192:195], v[84:87]
    v_perm_b32 v228, v214, v214, v8
    v_perm_b32 v229, v214, v214, v9
    v_perm_b32 v230, v214, v214, v10
    v_perm_b32 v231, v214, v214, v11
    s_waitcnt lgkmcnt(2)
    v_mfma_f32_16x16x32_bf16 v[80:83], v[224:227], v[196:199], v[80:83]
    v_perm_b32 v216, v211, v211, v4
    v_perm_b32 v217, v211, v211, v5
    v_perm_b32 v218, v211, v211, v6
    v_perm_b32 v219, v211, v211, v7
    v_mfma_f32_16x16x32_bf16 v[84:87], v[228:231], v[196:199], v[84:87]
    v_perm_b32 v220, v215, v215, v4
    v_perm_b32 v221, v215, v215, v5
    v_perm_b32 v222, v215, v215, v6
    v_perm_b32 v223, v215, v215, v7
    s_waitcnt lgkmcnt(1)
    v_mfma_f32_16x16x32_bf16 v[80:83], v[216:219], v[200:203], v[80:83]
    v_perm_b32 v224, v211, v211, v8
    v_perm_b32 v225, v211, v211, v9
    v_perm_b32 v226, v211, v211, v10
    v_perm_b32 v227, v211, v211, v11
    v_mfma_f32_16x16x32_bf16 v[84:87], v[220:223], v[200:203], v[84:87]
    v_perm_b32 v228, v215, v215, v8
    v_perm_b32 v229, v215, v215, v9
    v_perm_b32 v230, v215, v215, v10
    v_perm_b32 v231, v215, v215, v11
    s_waitcnt lgkmcnt(0)
    v_mfma_f32_16x16x32_bf16 v[80:83], v[224:227], v[204:207], v[80:83]
    s_nop 1
    v_mfma_f32_16x16x32_bf16 v[84:87], v[228:231], v[204:207], v[84:87]
    s_nop 1
    s_nop 7
    s_nop 1
    s_lshl_b32 s65, s72, 11
    s_add_u32 s65, s65, 155648
    v_lshlrev_b32 v33, 4, v1
    v_add_u32 v33, s65, v33
    ds_write_b128 v33, v[80:83]
    ds_write_b128 v33, v[84:87] offset:1024
    s_lshl_b32 s65, s72, 5
    s_add_u32 s65, s65, 153344
    v_lshlrev_b32 v33, 3, v2
    v_add_u32 v33, s65, v33
    v_cmp_gt_u32 vcc, 4, v1
    s_and_saveexec_b64 s[70:71], vcc
    ds_write_b64 v33, v[244:245]
    s_mov_b64 exec, s[70:71]
    s_waitcnt lgkmcnt(0)
    v_mov_b32 v33, 152592
    v_mov_b32 v34, 1
    s_mov_b64 exec, 1
    ds_add_rtn_u32 v35, v33, v34
    s_waitcnt lgkmcnt(0)
    s_mov_b64 exec, -1
    v_readfirstlane_b32 s65, v35
    s_nop 1
    s_cmp_lg_u32 s65, 3
    s_cbranch_scc1 .Lt47end

    v_lshlrev_b32 v33, 4, v1
    v_add_u32 v33, 155648, v33
    v_lshrrev_b32 v34, 1, v3
    v_lshlrev_b32 v34, 3, v34
    v_add_u32 v34, 153344, v34

    ds_read_b128 v[80:83], v33 offset:0
    ds_read_b128 v[84:87], v33 offset:1024
    ds_read_b128 v[88:91], v33 offset:2048
    ds_read_b128 v[92:95], v33 offset:3072
    ds_read_b128 v[96:99], v33 offset:4096
    ds_read_b128 v[100:103], v33 offset:5120
    ds_read_b128 v[104:107], v33 offset:6144
    ds_read_b128 v[108:111], v33 offset:7168
    s_waitcnt lgkmcnt(4)
    ds_read_b64 v[112:113], v34 offset:0
    ds_read_b64 v[114:115], v34 offset:16
    ds_read_b64 v[116:117], v34 offset:32
    ds_read_b64 v[118:119], v34 offset:48
    ds_read_b64 v[120:121], v34 offset:64
    ds_read_b64 v[122:123], v34 offset:80
    ds_read_b64 v[124:125], v34 offset:96
    ds_read_b64 v[126:127], v34 offset:112
    s_waitcnt lgkmcnt(0)
    v_max3_f32 v128, v112, v116, v120
    v_max_f32 v128, v128, v124
    v_sub_f32 v129, v112, v128
    v_sub_f32 v130, v116, v128
    v_sub_f32 v131, v120, v128
    v_sub_f32 v132, v124, v128
    v_exp_f32 v129, v129
    v_exp_f32 v130, v130
    v_exp_f32 v131, v131
    v_exp_f32 v132, v132
    s_nop 0
    v_mul_f32 v133, v129, v113
    v_fmac_f32 v133, v130, v117
    v_fmac_f32 v133, v131, v121
    v_fmac_f32 v133, v132, v125
    v_mul_f32 v134, v129, v80
    v_fmac_f32 v134, v130, v88
    v_fmac_f32 v134, v131, v96
    v_fmac_f32 v134, v132, v104
    v_mul_f32 v135, v129, v81
    v_fmac_f32 v135, v130, v89
    v_fmac_f32 v135, v131, v97
    v_fmac_f32 v135, v132, v105
    v_mul_f32 v136, v129, v82
    v_fmac_f32 v136, v130, v90
    v_fmac_f32 v136, v131, v98
    v_fmac_f32 v136, v132, v106
    v_mul_f32 v137, v129, v83
    v_fmac_f32 v137, v130, v91
    v_fmac_f32 v137, v131, v99
    v_fmac_f32 v137, v132, v107
    v_cvt_pk_bf16_f32 v208, v134, v135
    v_cvt_pk_bf16_f32 v210, v136, v137
    v_mov_b32 v209, s44
    v_mov_b32 v211, s44
    v_mov_b32 v212, v128
    v_mov_b32 v213, s44
    v_mov_b32 v214, v133
    v_mov_b32 v215, s44
    v_max3_f32 v128, v114, v118, v122
    v_max_f32 v128, v128, v126
    v_sub_f32 v129, v114, v128
    v_sub_f32 v130, v118, v128
    v_sub_f32 v131, v122, v128
    v_sub_f32 v132, v126, v128
    v_exp_f32 v129, v129
    v_exp_f32 v130, v130
    v_exp_f32 v131, v131
    v_exp_f32 v132, v132
    s_nop 0
    v_mul_f32 v133, v129, v115
    v_fmac_f32 v133, v130, v119
    v_fmac_f32 v133, v131, v123
    v_fmac_f32 v133, v132, v127
    v_mul_f32 v134, v129, v84
    v_fmac_f32 v134, v130, v92
    v_fmac_f32 v134, v131, v100
    v_fmac_f32 v134, v132, v108
    v_mul_f32 v135, v129, v85
    v_fmac_f32 v135, v130, v93
    v_fmac_f32 v135, v131, v101
    v_fmac_f32 v135, v132, v109
    v_mul_f32 v136, v129, v86
    v_fmac_f32 v136, v130, v94
    v_fmac_f32 v136, v131, v102
    v_fmac_f32 v136, v132, v110
    v_mul_f32 v137, v129, v87
    v_fmac_f32 v137, v130, v95
    v_fmac_f32 v137, v131, v103
    v_fmac_f32 v137, v132, v111
    v_cvt_pk_bf16_f32 v216, v134, v135
    v_cvt_pk_bf16_f32 v218, v136, v137
    v_mov_b32 v217, s44
    v_mov_b32 v219, s44
    v_mov_b32 v220, v128
    v_mov_b32 v221, s44
    v_mov_b32 v222, v133
    v_mov_b32 v223, s44
    s_lshr_b32 s64, s2, 7
    s_lshl_b32 s64, s64, 5
    s_and_b32 s65, s2, 7
    s_lshl_b32 s65, s65, 2
    s_add_u32 s64, s64, s65
    s_lshl_b32 s64, s64, 4
    s_bfe_u32 s65, s2, 0x40003
    s_add_u32 s64, s64, s65
    s_lshl_b32 s66, s64, 9
    s_add_u32 s66, s66, 1310720
    s_add_u32 s67, s66, 16384
    s_lshl_b32 s68, s64, 4
    s_add_u32 s68, s68, 1835008
    v_lshrrev_b32 v33, 1, v3
    v_lshlrev_b32 v34, 13, v33
    v_lshl_add_u32 v34, v2, 5, v34
    v_and_b32 v35, 1, v3
    v_lshl_add_u32 v34, v35, 4, v34
    buffer_store_dwordx4 v[208:211], v34, s[48:51], s66 offen sc1
    buffer_store_dwordx4 v[216:219], v34, s[48:51], s67 offen sc1
    v_lshlrev_b32 v33, 8, v33
    v_and_b32 v35, 31, v1
    v_cmp_eq_u32 vcc, 0, v35
    s_and_saveexec_b64 s[70:71], vcc
    buffer_store_dwordx4 v[212:215], v33, s[48:51], s68 offen sc1
    buffer_store_dwordx4 v[220:223], v33, s[48:51], s68 offen offset:512 sc1
    s_mov_b64 exec, s[70:71]
    s_and_b32 s64, s2, 7
    s_lshl_b32 s64, s64, 9
    s_lshr_b32 s65, s2, 7
    s_lshl_b32 s65, s65, 5
    s_add_u32 s64, s64, s65
    s_bfe_u32 s65, s2, 0x30004
    s_lshl_b32 s65, s65, 2
    s_add_u32 s64, s64, s65
    s_add_u32 s64, s64, 81920

    s_bitcmp1_b32 s2, 3
    s_cbranch_scc0 .pf_136
    v_lshlrev_b32 v47, 7, v1
    v_mov_b32 v46, s44
    s_mov_b64 exec, 15
    buffer_store_dword v46, v47, s[48:51], s64 offen sc1
    s_mov_b64 exec, -1
.pf_136:
.Lt47end:
    s_branch .Lend
.Lend:
    s_endpgm
.section .rodata,"a"
.p2align 6
.amdhsa_kernel concat_heads__compressed_kv_cla__sliding_block_cached__decode_kernel
  .amdhsa_next_free_vgpr 256
  .amdhsa_next_free_sgpr 102
  .amdhsa_accum_offset 256
  .amdhsa_group_segment_fixed_size 0
  .amdhsa_kernarg_size 112
  .amdhsa_user_sgpr_count 2
  .amdhsa_user_sgpr_kernarg_segment_ptr 1
  .amdhsa_system_sgpr_workgroup_id_x 1
.end_amdhsa_kernel
```
